```python
import torch

def _softmax(x, axis=-1):
    return torch.softmax(x, dim=axis)
def _gelu(x):
    return torch.nn.functional.gelu(x, approximate="tanh")
def _silu(x):
    return torch.nn.functional.silu(x)
def _sigmoid(x):
    return torch.sigmoid(x)
def _layernorm(x, axis=-1, eps=1e-5):
    m = x.mean(dim=axis, keepdim=True)
    v = x.var(dim=axis, keepdim=True, unbiased=False)
    return (x - m) / torch.sqrt(v + eps)
def _scatter_add(tgt, idx, src, axis=0):
    return tgt.clone().index_add_(axis, idx, src)
def _segment_sum(src, seg, n):
    out = torch.zeros((n,) + src.shape[1:], dtype=src.dtype)
    return out.index_add_(0, seg, src)
def _pad(x, pw):
    flat = tuple(v for pair in reversed(pw) for v in pair)
    return torch.nn.functional.pad(x, flat)

kernel_name = 'concat_heads__compressed_kv_cla__compressed_kv_cla__decode'

def setup_inputs():

    _w = (lambda a: (lambda t: t.to(torch.bfloat16) if t.is_floating_point() else t)(torch.as_tensor(a)))
    def _A_setup():
        B, H, Sq, Sk, D, M = 2, 16, 1, 4096, 256, 448
        Dc = 4 * D
        return {
            "x": _w((lambda *s: torch.randn(*s, dtype=torch.bfloat16) * 3.2)(B, Sq, M)),
            "c_kv": _w((lambda *s: torch.randn(*s, dtype=torch.bfloat16) * 0.05)(B, Sk, Dc)),
            "w_q": _w((lambda *s: torch.randn(*s, dtype=torch.bfloat16) * 3.2)(M, H, D) * (M ** -0.5)),
            "w_uk": _w((lambda *s: torch.randn(*s, dtype=torch.bfloat16) * 3.2)(Dc, H, D) * (Dc ** -0.5)),
            "w_uv": _w((lambda *s: torch.randn(*s, dtype=torch.bfloat16) * 0.05)(Dc, H, D) * (Dc ** -0.5)),
            "w_o": _w((lambda *s: torch.randn(*s, dtype=torch.bfloat16) * 0.05)(H, D, M) * ((H * D) ** -0.5)),
        }
    _A_in = _A_setup()

    def _B_setup():
        B, H, Sq, Sk, D, M = 2, 16, 1, 4096, 256, 448
        Dc = 4 * D
        return {
            "x": _w((lambda *s: torch.randn(*s, dtype=torch.bfloat16) * 3.2)(B, Sq, M)),
            "c_kv": _w((lambda *s: torch.randn(*s, dtype=torch.bfloat16) * 0.05)(B, Sk, Dc)),
            "w_q": _w((lambda *s: torch.randn(*s, dtype=torch.bfloat16) * 3.2)(M, H, D) * (M ** -0.5)),
            "w_uk": _w((lambda *s: torch.randn(*s, dtype=torch.bfloat16) * 3.2)(Dc, H, D) * (Dc ** -0.5)),
            "w_uv": _w((lambda *s: torch.randn(*s, dtype=torch.bfloat16) * 0.05)(Dc, H, D) * (Dc ** -0.5)),
            "w_o": _w((lambda *s: torch.randn(*s, dtype=torch.bfloat16) * 0.05)(H, D, M) * ((H * D) ** -0.5)),
        }
    _B_in = _B_setup()

    return {
        "A_x": _A_in["x"],
        "A_c_kv": _A_in["c_kv"],
        "A_w_q": _A_in["w_q"],
        "A_w_uk": _A_in["w_uk"],
        "A_w_uv": _A_in["w_uv"],
        "A_w_o": _A_in["w_o"],
        "B_x": _B_in["x"],
        "B_c_kv": _B_in["c_kv"],
        "B_w_q": _B_in["w_q"],
        "B_w_uk": _B_in["w_uk"],
        "B_w_uv": _B_in["w_uv"],
        "B_w_o": _B_in["w_o"],
    }

def reference(A_x, A_c_kv, A_w_q, A_w_uk, A_w_uv, A_w_o, B_x, B_c_kv, B_w_q, B_w_uk, B_w_uv, B_w_o):
    def _A_ref(x, c_kv, w_q, w_uk, w_uv, w_o):
        B, Sq, M = x.shape[0], x.shape[1], x.shape[2]
        Sk = c_kv.shape[1]
        H, D = w_q.shape[1], w_q.shape[2]
        q = torch.einsum("bqm,mhd->bhqd", x, w_q)
        k = torch.einsum("bkc,chd->bhkd", c_kv, w_uk)
        v = torch.einsum("bkc,chd->bhkd", c_kv, w_uv)
        scores = torch.einsum("bhqd,bhkd->bhqk", q, k) * (D ** -0.5)
        off = Sk - Sq
        qi = torch.arange(Sq)[:, None]
        kj = torch.arange(Sk)[None, :]
        cmask = kj <= (qi + off)
        scores = torch.where(cmask[None, None], scores, -1e9)
        p = _softmax(scores, axis=-1)
        ctx = torch.einsum("bhqk,bhkd->bhqd", p, v)
        return torch.einsum("bhqd,hdm->bqm", ctx, w_o)

    def _B_ref(x, c_kv, w_q, w_uk, w_uv, w_o):
        B, Sq, M = x.shape[0], x.shape[1], x.shape[2]
        Sk = c_kv.shape[1]
        H, D = w_q.shape[1], w_q.shape[2]
        q = torch.einsum("bqm,mhd->bhqd", x, w_q)
        k = torch.einsum("bkc,chd->bhkd", c_kv, w_uk)
        v = torch.einsum("bkc,chd->bhkd", c_kv, w_uv)
        scores = torch.einsum("bhqd,bhkd->bhqk", q, k) * (D ** -0.5)
        off = Sk - Sq
        qi = torch.arange(Sq)[:, None]
        kj = torch.arange(Sk)[None, :]
        cmask = kj <= (qi + off)
        scores = torch.where(cmask[None, None], scores, -1e9)
        p = _softmax(scores, axis=-1)
        ctx = torch.einsum("bhqk,bhkd->bhqd", p, v)
        return torch.einsum("bhqd,hdm->bqm", ctx, w_o)

    a = _A_ref(A_x, A_c_kv, A_w_q, A_w_uk, A_w_uv, A_w_o)
    b = _B_ref(B_x, B_c_kv, B_w_q, B_w_uk, B_w_uv, B_w_o)
    return torch.concatenate([a, b], axis=-1)
```

```asm
; @launch grid=(256,1,1) block=(512,1,1) lds=163840
.amdgcn_target "amdgcn-amd-amdhsa--gfx950"
.text
.globl concat_heads__compressed_kv_cla__compressed_kv_cla__decode_kernel
.p2align 8
.type concat_heads__compressed_kv_cla__compressed_kv_cla__decode_kernel,@function
concat_heads__compressed_kv_cla__compressed_kv_cla__decode_kernel:
s_cmp_ge_u32 s2, 256
s_cbranch_scc1 L_end
s_and_b32 s16, s2, 7
s_lshr_b32 s17, s2, 6
s_lshl_b32 s18, s16, 2
s_add_u32 s18, s18, s17
s_lshr_b32 s4, s18, 4
s_mul_i32 s10, s4, 48
s_load_dwordx2 s[12:13], s[0:1], 112
s_load_dwordx2 s[36:37], s[0:1], s10 offset:0
s_load_dwordx2 s[44:45], s[0:1], s10 offset:16
s_load_dwordx2 s[48:49], s[0:1], s10 offset:24
s_load_dwordx2 s[40:41], s[0:1], s10 offset:8
s_load_dwordx2 s[52:53], s[0:1], s10 offset:32
s_load_dwordx2 s[56:57], s[0:1], s10 offset:40
s_and_b32 s5, s18, 15
s_lshr_b32 s16, s2, 3
s_and_b32 s6, s16, 7
s_lshl_b32 s9, s5, 3
s_add_u32 s9, s9, s6
s_lshr_b32 s7, s9, 6
s_and_b32 s8, s9, 63
v_and_b32 v1, 63, v0
v_and_b32 v2, 15, v0
v_bfe_u32 v3, v0, 4, 2
v_lshrrev_b32 v13, 6, v0
s_nop 0
v_readfirstlane_b32 s3, v13
s_mov_b32 s38, 1792
s_mov_b32 s39, 0x00020000
s_mov_b32 s42, 16777216
s_mov_b32 s43, 0x00020000
s_mov_b32 s46, 3670016
s_mov_b32 s47, 0x00020000
s_mov_b32 s50, 8388608
s_mov_b32 s51, 0x00020000
s_mov_b32 s54, 8388608
s_mov_b32 s55, 0x00020000
s_mov_b32 s58, 3670016
s_mov_b32 s59, 0x00020000
s_mov_b32 s14, 268435456
s_mov_b32 s15, 0x00020000
s_and_b32 s27, s3, 3
v_lshlrev_b32 v12, 4, v1
v_lshlrev_b32 v14, 4, v2
v_mov_b32 v30, 161792
v_mov_b32 v31, 1
v_lshlrev_b32 v15, 6, v13
v_add_u32 v15, 162048, v15
v_lshlrev_b32 v13, 2, v1
v_add_u32 v13, 161792, v13
v_mov_b32 v29, 0
ds_write_b32 v13, v29
s_lshl_b32 s21, s5, 9
s_lshl_b32 s19, s4, 7
s_add_u32 s19, s19, s9
s_mul_i32 s19, s19, 40960
s_add_u32 s19, s19, 1048576
s_mul_i32 s20, s4, 56
s_add_u32 s20, s20, s9
s_lshl_b32 s20, s20, 13
s_add_u32 s20, s20, 20971520
s_lshl_b32 s16, s27, 2
v_add_u32 v28, s16, v30
s_waitcnt lgkmcnt(0)
s_lshl_b32 s16, s4, 8
s_add_u32 s16, s16, 524288
s_load_dword s11, s[12:13], s16
s_cmp_ge_u32 s3, 4
s_cbranch_scc1 L_G1
s_setprio 2
v_lshlrev_b32 v16, 13, v2
v_lshl_add_u32 v16, v3, 4, v16
s_lshl_b32 s16, s6, 2
s_add_u32 s16, s16, s27
s_lshl_b32 s16, s16, 18
s_add_u32 s16, s16, s21
s_barrier
buffer_load_dwordx4 v[80:83], v16, s[48:51], s16 offen offset:0 nt
buffer_load_dwordx4 v[84:87], v16, s[48:51], s16 offen offset:64 nt
buffer_load_dwordx4 v[88:91], v16, s[48:51], s16 offen offset:128 nt
buffer_load_dwordx4 v[92:95], v16, s[48:51], s16 offen offset:192 nt
buffer_load_dwordx4 v[96:99], v16, s[48:51], s16 offen offset:256 nt
buffer_load_dwordx4 v[100:103], v16, s[48:51], s16 offen offset:320 nt
buffer_load_dwordx4 v[104:107], v16, s[48:51], s16 offen offset:384 nt
buffer_load_dwordx4 v[108:111], v16, s[48:51], s16 offen offset:448 nt
s_add_u32 s16, s16, 131072
buffer_load_dwordx4 v[112:115], v16, s[48:51], s16 offen offset:0 nt
buffer_load_dwordx4 v[116:119], v16, s[48:51], s16 offen offset:64 nt
buffer_load_dwordx4 v[120:123], v16, s[48:51], s16 offen offset:128 nt
buffer_load_dwordx4 v[124:127], v16, s[48:51], s16 offen offset:192 nt
buffer_load_dwordx4 v[128:131], v16, s[48:51], s16 offen offset:256 nt
buffer_load_dwordx4 v[132:135], v16, s[48:51], s16 offen offset:320 nt
buffer_load_dwordx4 v[136:139], v16, s[48:51], s16 offen offset:384 nt
buffer_load_dwordx4 v[140:143], v16, s[48:51], s16 offen offset:448 nt
s_setprio 3
s_waitcnt lgkmcnt(0)
s_mul_i32 s11, s11, 0x9E3779B1
s_add_u32 s11, s11, 0x7F4A7C15
s_mov_b32 s34, s11
s_mov_b32 s35, s11
s_lshl_b32 s25, s18, 11
s_lshl_b32 s16, s27, 9
s_add_u32 s25, s25, s16
s_add_u32 s25, s25, 262144
s_mov_b32 s24, 100000
L_qv0_1:
s_load_dwordx16 s[36:51], s[12:13], s25 offset:0 glc
s_load_dwordx16 s[52:67], s[12:13], s25 offset:64 glc
s_load_dwordx16 s[68:83], s[12:13], s25 offset:128 glc
s_load_dwordx16 s[84:99], s[12:13], s25 offset:192 glc
s_waitcnt lgkmcnt(0)
s_xor_b32 s28, s37, s11
s_xor_b32 s29, s39, s11
s_or_b32 s28, s28, s29
s_xor_b32 s29, s41, s11
s_or_b32 s28, s28, s29
s_xor_b32 s29, s43, s11
s_or_b32 s28, s28, s29
s_xor_b32 s29, s45, s11
s_or_b32 s28, s28, s29
s_xor_b32 s29, s47, s11
s_or_b32 s28, s28, s29
s_xor_b32 s29, s49, s11
s_or_b32 s28, s28, s29
s_xor_b32 s29, s51, s11
s_or_b32 s28, s28, s29
s_xor_b32 s29, s53, s11
s_or_b32 s28, s28, s29
s_xor_b32 s29, s55, s11
s_or_b32 s28, s28, s29
s_xor_b32 s29, s57, s11
s_or_b32 s28, s28, s29
s_xor_b32 s29, s59, s11
s_or_b32 s28, s28, s29
s_xor_b32 s29, s61, s11
s_or_b32 s28, s28, s29
s_xor_b32 s29, s63, s11
s_or_b32 s28, s28, s29
s_xor_b32 s29, s65, s11
s_or_b32 s28, s28, s29
s_xor_b32 s29, s67, s11
s_or_b32 s28, s28, s29
s_xor_b32 s29, s69, s11
s_or_b32 s28, s28, s29
s_xor_b32 s29, s71, s11
s_or_b32 s28, s28, s29
s_xor_b32 s29, s73, s11
s_or_b32 s28, s28, s29
s_xor_b32 s29, s75, s11
s_or_b32 s28, s28, s29
s_xor_b32 s29, s77, s11
s_or_b32 s28, s28, s29
s_xor_b32 s29, s79, s11
s_or_b32 s28, s28, s29
s_xor_b32 s29, s81, s11
s_or_b32 s28, s28, s29
s_xor_b32 s29, s83, s11
s_or_b32 s28, s28, s29
s_xor_b32 s29, s85, s11
s_or_b32 s28, s28, s29
s_xor_b32 s29, s87, s11
s_or_b32 s28, s28, s29
s_xor_b32 s29, s89, s11
s_or_b32 s28, s28, s29
s_xor_b32 s29, s91, s11
s_or_b32 s28, s28, s29
s_xor_b32 s29, s93, s11
s_or_b32 s28, s28, s29
s_xor_b32 s29, s95, s11
s_or_b32 s28, s28, s29
s_xor_b32 s29, s97, s11
s_or_b32 s28, s28, s29
s_xor_b32 s29, s99, s11
s_or_b32 s28, s28, s29
s_cmp_eq_u32 s28, 0
s_cbranch_scc1 L_qv0d_2
s_sub_u32 s24, s24, 1
s_cmp_eq_u32 s24, 0
s_cbranch_scc1 L_qv0d_2
s_sleep 1
s_branch L_qv0_1
L_qv0d_2:
v_writelane_b32 v32, s36, 0
v_writelane_b32 v32, s38, 1
v_writelane_b32 v32, s40, 2
v_writelane_b32 v32, s42, 3
v_writelane_b32 v32, s44, 4
v_writelane_b32 v32, s46, 5
v_writelane_b32 v32, s48, 6
v_writelane_b32 v32, s50, 7
v_writelane_b32 v32, s52, 8
v_writelane_b32 v32, s54, 9
v_writelane_b32 v32, s56, 10
v_writelane_b32 v32, s58, 11
v_writelane_b32 v32, s60, 12
v_writelane_b32 v32, s62, 13
v_writelane_b32 v32, s64, 14
v_writelane_b32 v32, s66, 15
v_writelane_b32 v32, s68, 16
v_writelane_b32 v32, s70, 17
v_writelane_b32 v32, s72, 18
v_writelane_b32 v32, s74, 19
v_writelane_b32 v32, s76, 20
v_writelane_b32 v32, s78, 21
v_writelane_b32 v32, s80, 22
v_writelane_b32 v32, s82, 23
v_writelane_b32 v32, s84, 24
v_writelane_b32 v32, s86, 25
v_writelane_b32 v32, s88, 26
v_writelane_b32 v32, s90, 27
v_writelane_b32 v32, s92, 28
v_writelane_b32 v32, s94, 29
v_writelane_b32 v32, s96, 30
v_writelane_b32 v32, s98, 31
s_add_u32 s25, s25, 256
s_mov_b32 s24, 100000
L_qv1_3:
s_load_dwordx16 s[36:51], s[12:13], s25 offset:0 glc
s_load_dwordx16 s[52:67], s[12:13], s25 offset:64 glc
s_load_dwordx16 s[68:83], s[12:13], s25 offset:128 glc
s_load_dwordx16 s[84:99], s[12:13], s25 offset:192 glc
s_waitcnt lgkmcnt(0)
s_xor_b32 s28, s37, s11
s_xor_b32 s29, s39, s11
s_or_b32 s28, s28, s29
s_xor_b32 s29, s41, s11
s_or_b32 s28, s28, s29
s_xor_b32 s29, s43, s11
s_or_b32 s28, s28, s29
s_xor_b32 s29, s45, s11
s_or_b32 s28, s28, s29
s_xor_b32 s29, s47, s11
s_or_b32 s28, s28, s29
s_xor_b32 s29, s49, s11
s_or_b32 s28, s28, s29
s_xor_b32 s29, s51, s11
s_or_b32 s28, s28, s29
s_xor_b32 s29, s53, s11
s_or_b32 s28, s28, s29
s_xor_b32 s29, s55, s11
s_or_b32 s28, s28, s29
s_xor_b32 s29, s57, s11
s_or_b32 s28, s28, s29
s_xor_b32 s29, s59, s11
s_or_b32 s28, s28, s29
s_xor_b32 s29, s61, s11
s_or_b32 s28, s28, s29
s_xor_b32 s29, s63, s11
s_or_b32 s28, s28, s29
s_xor_b32 s29, s65, s11
s_or_b32 s28, s28, s29
s_xor_b32 s29, s67, s11
s_or_b32 s28, s28, s29
s_xor_b32 s29, s69, s11
s_or_b32 s28, s28, s29
s_xor_b32 s29, s71, s11
s_or_b32 s28, s28, s29
s_xor_b32 s29, s73, s11
s_or_b32 s28, s28, s29
s_xor_b32 s29, s75, s11
s_or_b32 s28, s28, s29
s_xor_b32 s29, s77, s11
s_or_b32 s28, s28, s29
s_xor_b32 s29, s79, s11
s_or_b32 s28, s28, s29
s_xor_b32 s29, s81, s11
s_or_b32 s28, s28, s29
s_xor_b32 s29, s83, s11
s_or_b32 s28, s28, s29
s_xor_b32 s29, s85, s11
s_or_b32 s28, s28, s29
s_xor_b32 s29, s87, s11
s_or_b32 s28, s28, s29
s_xor_b32 s29, s89, s11
s_or_b32 s28, s28, s29
s_xor_b32 s29, s91, s11
s_or_b32 s28, s28, s29
s_xor_b32 s29, s93, s11
s_or_b32 s28, s28, s29
s_xor_b32 s29, s95, s11
s_or_b32 s28, s28, s29
s_xor_b32 s29, s97, s11
s_or_b32 s28, s28, s29
s_xor_b32 s29, s99, s11
s_or_b32 s28, s28, s29
s_cmp_eq_u32 s28, 0
s_cbranch_scc1 L_qv1d_4
s_sub_u32 s24, s24, 1
s_cmp_eq_u32 s24, 0
s_cbranch_scc1 L_qv1d_4
s_sleep 1
s_branch L_qv1_3
L_qv1d_4:
v_writelane_b32 v32, s36, 32
v_writelane_b32 v32, s38, 33
v_writelane_b32 v32, s40, 34
v_writelane_b32 v32, s42, 35
v_writelane_b32 v32, s44, 36
v_writelane_b32 v32, s46, 37
v_writelane_b32 v32, s48, 38
v_writelane_b32 v32, s50, 39
v_writelane_b32 v32, s52, 40
v_writelane_b32 v32, s54, 41
v_writelane_b32 v32, s56, 42
v_writelane_b32 v32, s58, 43
v_writelane_b32 v32, s60, 44
v_writelane_b32 v32, s62, 45
v_writelane_b32 v32, s64, 46
v_writelane_b32 v32, s66, 47
v_writelane_b32 v32, s68, 48
v_writelane_b32 v32, s70, 49
v_writelane_b32 v32, s72, 50
v_writelane_b32 v32, s74, 51
v_writelane_b32 v32, s76, 52
v_writelane_b32 v32, s78, 53
v_writelane_b32 v32, s80, 54
v_writelane_b32 v32, s82, 55
v_writelane_b32 v32, s84, 56
v_writelane_b32 v32, s86, 57
v_writelane_b32 v32, s88, 58
v_writelane_b32 v32, s90, 59
v_writelane_b32 v32, s92, 60
v_writelane_b32 v32, s94, 61
v_writelane_b32 v32, s96, 62
v_writelane_b32 v32, s98, 63
v_lshlrev_b32 v17, 1, v0
v_add_u32 v17, 147456, v17
ds_write_b16 v17, v32
ds_write_b16_d16_hi v17, v32 offset:512
s_waitcnt lgkmcnt(0)
s_mov_b64 exec, 1
ds_add_u32 v30, v31 offset:4
s_mov_b64 exec, -1
s_mov_b32 s24, 2000000
L_w_5:
ds_read_b32 v29, v30 offset:4
s_waitcnt lgkmcnt(0)
v_readfirstlane_b32 s17, v29
s_sub_u32 s24, s24, 1
s_cmp_eq_u32 s24, 0
s_cbranch_scc1 L_wd_6
s_cmp_ge_u32 s17, 4
s_cbranch_scc1 L_wd_6
s_branch L_w_5
L_wd_6:
v_and_b32 v17, 1, v2
v_lshlrev_b32 v17, 9, v17
v_lshl_add_u32 v17, v3, 4, v17
v_add_u32 v17, 147456, v17
ds_read_b128 v[32:35], v17 offset:0
ds_read_b128 v[36:39], v17 offset:64
ds_read_b128 v[40:43], v17 offset:128
ds_read_b128 v[44:47], v17 offset:192
ds_read_b128 v[48:51], v17 offset:256
ds_read_b128 v[52:55], v17 offset:320
ds_read_b128 v[56:59], v17 offset:384
ds_read_b128 v[60:63], v17 offset:448
s_waitcnt lgkmcnt(0)
s_waitcnt vmcnt(0)
v_mfma_f32_16x16x32_bf16 v[176:179], v[80:83], v[32:35], 0
v_mfma_f32_16x16x32_bf16 v[180:183], v[112:115], v[32:35], 0
v_mfma_f32_16x16x32_bf16 v[176:179], v[84:87], v[36:39], v[176:179]
v_mfma_f32_16x16x32_bf16 v[180:183], v[116:119], v[36:39], v[180:183]
v_mfma_f32_16x16x32_bf16 v[176:179], v[88:91], v[40:43], v[176:179]
v_mfma_f32_16x16x32_bf16 v[180:183], v[120:123], v[40:43], v[180:183]
v_mfma_f32_16x16x32_bf16 v[176:179], v[92:95], v[44:47], v[176:179]
v_mfma_f32_16x16x32_bf16 v[180:183], v[124:127], v[44:47], v[180:183]
v_mfma_f32_16x16x32_bf16 v[176:179], v[96:99], v[48:51], v[176:179]
v_mfma_f32_16x16x32_bf16 v[180:183], v[128:131], v[48:51], v[180:183]
v_mfma_f32_16x16x32_bf16 v[176:179], v[100:103], v[52:55], v[176:179]
v_mfma_f32_16x16x32_bf16 v[180:183], v[132:135], v[52:55], v[180:183]
v_mfma_f32_16x16x32_bf16 v[176:179], v[104:107], v[56:59], v[176:179]
v_mfma_f32_16x16x32_bf16 v[180:183], v[136:139], v[56:59], v[180:183]
v_mfma_f32_16x16x32_bf16 v[176:179], v[108:111], v[60:63], v[176:179]
v_mfma_f32_16x16x32_bf16 v[180:183], v[140:143], v[60:63], v[180:183]
v_lshlrev_b32 v17, 15, v2
v_lshl_add_u32 v17, v3, 3, v17
s_lshl_b32 s16, s4, 16
s_lshl_b32 s17, s5, 11
s_add_u32 s16, s16, s17
s_lshl_b32 s17, s6, 8
s_add_u32 s16, s16, s17
s_lshl_b32 s17, s27, 6
s_add_u32 s16, s16, s17
v_mov_b32 v32, 0x3db8aa3b
s_nop 1
v_mul_f32 v176, v32, v176
v_mul_f32 v177, v32, v177
v_mul_f32 v178, v32, v178
v_mul_f32 v179, v32, v179
v_mul_f32 v180, v32, v180
v_mul_f32 v181, v32, v181
v_mul_f32 v182, v32, v182
v_mul_f32 v183, v32, v183
v_cvt_pk_bf16_f32 v184, v176, v177
v_cvt_pk_bf16_f32 v185, v178, v179
v_cvt_pk_bf16_f32 v186, v180, v181
v_cvt_pk_bf16_f32 v187, v182, v183
v_cmp_gt_u32 vcc, 2, v2
s_and_saveexec_b64 s[22:23], vcc
buffer_store_dwordx2 v[184:185], v17, s[12:15], s16 offen offset:0 sc1
buffer_store_dwordx2 v[186:187], v17, s[12:15], s16 offen offset:32 sc1
s_mov_b64 exec, s[22:23]
s_lshl_b32 s33, s27, 15
v_add_u32 v4, 0, v3
v_xor_b32 v4, v4, v2
v_lshlrev_b32 v4, 4, v4
v_lshl_add_u32 v4, v2, 8, v4
v_add_u32 v4, s33, v4
v_add_u32 v5, 4, v3
v_xor_b32 v5, v5, v2
v_lshlrev_b32 v5, 4, v5
v_lshl_add_u32 v5, v2, 8, v5
v_add_u32 v5, s33, v5
v_add_u32 v6, 8, v3
v_xor_b32 v6, v6, v2
v_lshlrev_b32 v6, 4, v6
v_lshl_add_u32 v6, v2, 8, v6
v_add_u32 v6, s33, v6
v_add_u32 v7, 12, v3
v_xor_b32 v7, v7, v2
v_lshlrev_b32 v7, 4, v7
v_lshl_add_u32 v7, v2, 8, v7
v_add_u32 v7, s33, v7
v_lshrrev_b32 v8, 2, v2
v_and_b32 v9, 3, v2
v_lshl_add_u32 v10, v3, 2, v8
v_lshlrev_b32 v10, 8, v10
v_add_u32 v10, s33, v10
v_xor_b32 v11, v9, v3
v_lshl_add_u32 v10, v11, 6, v10
v_and_b32 v9, 1, v9
v_xor_b32 v11, 0, v8
v_lshl_add_u32 v20, v11, 4, v10
v_xor_b32 v11, 0, v9
v_lshl_add_u32 v20, v11, 3, v20
v_xor_b32 v11, 0, v8
v_lshl_add_u32 v21, v11, 4, v10
v_xor_b32 v11, 1, v9
v_lshl_add_u32 v21, v11, 3, v21
v_xor_b32 v11, 1, v8
v_lshl_add_u32 v22, v11, 4, v10
v_xor_b32 v11, 0, v9
v_lshl_add_u32 v22, v11, 3, v22
v_xor_b32 v11, 1, v8
v_lshl_add_u32 v23, v11, 4, v10
v_xor_b32 v11, 1, v9
v_lshl_add_u32 v23, v11, 3, v23
v_xor_b32 v11, 2, v8
v_lshl_add_u32 v24, v11, 4, v10
v_xor_b32 v11, 0, v9
v_lshl_add_u32 v24, v11, 3, v24
v_xor_b32 v11, 2, v8
v_lshl_add_u32 v25, v11, 4, v10
v_xor_b32 v11, 1, v9
v_lshl_add_u32 v25, v11, 3, v25
v_xor_b32 v11, 3, v8
v_lshl_add_u32 v26, v11, 4, v10
v_xor_b32 v11, 0, v9
v_lshl_add_u32 v26, v11, 3, v26
v_xor_b32 v11, 3, v8
v_lshl_add_u32 v27, v11, 4, v10
v_xor_b32 v11, 1, v9
v_lshl_add_u32 v27, v11, 3, v27
s_mov_b32 s24, 2000000
L_w_7:
ds_read_b32 v29, v30 offset:12
s_waitcnt lgkmcnt(0)
v_readfirstlane_b32 s17, v29
s_sub_u32 s24, s24, 1
s_cmp_eq_u32 s24, 0
s_cbranch_scc1 L_wd_8
s_cmp_ge_u32 s17, 4
s_cbranch_scc1 L_wd_8
s_branch L_w_7
L_wd_8:
s_waitcnt vmcnt(0)
s_mov_b64 exec, 1
ds_add_rtn_u32 v29, v30, v31 offset:32
s_waitcnt lgkmcnt(0)
v_readfirstlane_b32 s17, v29
s_cmp_lg_u32 s17, 3
s_cbranch_scc1 L_nof2_9
s_mov_b64 exec, -1
s_mul_i32 s16, s4, 5242880
s_lshl_b32 s17, s6, 6
s_add_u32 s16, s16, s17
s_lshl_b32 s17, s5, 2
s_add_u32 s16, s16, s17
s_add_u32 s16, s16, 1083392
s_mov_b32 s17, 40960
v_mul_lo_u32 v17, v1, s17
v_mov_b32 v29, s11
buffer_store_dword v29, v17, s[12:15], s16 offen sc1
s_add_u32 s16, s16, 2621440
buffer_store_dword v29, v17, s[12:15], s16 offen sc1
L_nof2_9:
s_mov_b64 exec, -1
s_lshl_b32 s16, s27, 7
s_add_u32 s25, s19, s16
s_add_u32 s25, s25, 34816
v_lshlrev_b32 v18, 11, v2
v_lshl_add_u32 v18, v3, 4, v18
s_lshl_b32 s26, s4, 1
s_add_u32 s26, s26, s7
s_lshl_b32 s26, s26, 15
s_lshl_b32 s16, s27, 9
s_add_u32 s26, s26, s16
s_mov_b32 s24, 100000
L_f2_10:
s_load_dwordx16 s[36:51], s[12:13], s25 offset:0 glc
s_load_dwordx16 s[52:67], s[12:13], s25 offset:64 glc
s_waitcnt lgkmcnt(0)
s_xor_b64 s[28:29], s[36:37], s[34:35]
s_xor_b64 s[22:23], s[38:39], s[34:35]
s_or_b64 s[28:29], s[28:29], s[22:23]
s_xor_b64 s[22:23], s[40:41], s[34:35]
s_or_b64 s[28:29], s[28:29], s[22:23]
s_xor_b64 s[22:23], s[42:43], s[34:35]
s_or_b64 s[28:29], s[28:29], s[22:23]
s_xor_b64 s[22:23], s[44:45], s[34:35]
s_or_b64 s[28:29], s[28:29], s[22:23]
s_xor_b64 s[22:23], s[46:47], s[34:35]
s_or_b64 s[28:29], s[28:29], s[22:23]
s_xor_b64 s[22:23], s[48:49], s[34:35]
s_or_b64 s[28:29], s[28:29], s[22:23]
s_xor_b64 s[22:23], s[50:51], s[34:35]
s_or_b64 s[28:29], s[28:29], s[22:23]
s_xor_b64 s[22:23], s[52:53], s[34:35]
s_or_b64 s[28:29], s[28:29], s[22:23]
s_xor_b64 s[22:23], s[54:55], s[34:35]
s_or_b64 s[28:29], s[28:29], s[22:23]
s_xor_b64 s[22:23], s[56:57], s[34:35]
s_or_b64 s[28:29], s[28:29], s[22:23]
s_xor_b64 s[22:23], s[58:59], s[34:35]
s_or_b64 s[28:29], s[28:29], s[22:23]
s_xor_b64 s[22:23], s[60:61], s[34:35]
s_or_b64 s[28:29], s[28:29], s[22:23]
s_xor_b64 s[22:23], s[62:63], s[34:35]
s_or_b64 s[28:29], s[28:29], s[22:23]
s_xor_b64 s[22:23], s[64:65], s[34:35]
s_or_b64 s[28:29], s[28:29], s[22:23]
s_xor_b64 s[22:23], s[66:67], s[34:35]
s_or_b64 s[28:29], s[28:29], s[22:23]
s_cmp_eq_u64 s[28:29], 0
s_cbranch_scc1 L_f2d_11
s_sub_u32 s24, s24, 1
s_cmp_eq_u32 s24, 0
s_cbranch_scc1 L_f2d_11
s_sleep 2
s_branch L_f2_10
L_f2d_11:
buffer_load_dwordx4 v[32:35], v18, s[12:15], s26 offen offset:0 sc1
buffer_load_dwordx4 v[36:39], v18, s[12:15], s26 offen offset:64 sc1
buffer_load_dwordx4 v[40:43], v18, s[12:15], s26 offen offset:128 sc1
buffer_load_dwordx4 v[44:47], v18, s[12:15], s26 offen offset:192 sc1
buffer_load_dwordx4 v[48:51], v18, s[12:15], s26 offen offset:256 sc1
buffer_load_dwordx4 v[52:55], v18, s[12:15], s26 offen offset:320 sc1
buffer_load_dwordx4 v[56:59], v18, s[12:15], s26 offen offset:384 sc1
buffer_load_dwordx4 v[60:63], v18, s[12:15], s26 offen offset:448 sc1
s_mov_b32 s24, 2000000
L_w_12:
ds_read_b32 v29, v28 offset:64
s_waitcnt lgkmcnt(0)
v_readfirstlane_b32 s17, v29
s_sub_u32 s24, s24, 1
s_cmp_eq_u32 s24, 0
s_cbranch_scc1 L_wd_13
s_cmp_ge_u32 s17, 1
s_cbranch_scc1 L_wd_13
s_sleep 1
s_branch L_w_12
L_wd_13:
ds_read_b128 v[64:67], v4 offset:0
ds_read_b128 v[68:71], v5 offset:0
ds_read_b128 v[72:75], v6 offset:0
ds_read_b128 v[76:79], v7 offset:0
ds_read_b128 v[80:83], v4 offset:4096
ds_read_b128 v[84:87], v5 offset:4096
ds_read_b128 v[88:91], v6 offset:4096
ds_read_b128 v[92:95], v7 offset:4096
ds_read_b128 v[96:99], v4 offset:8192
ds_read_b128 v[100:103], v5 offset:8192
ds_read_b128 v[104:107], v6 offset:8192
ds_read_b128 v[108:111], v7 offset:8192
ds_read_b128 v[112:115], v4 offset:12288
ds_read_b128 v[116:119], v5 offset:12288
ds_read_b128 v[120:123], v6 offset:12288
ds_read_b128 v[124:127], v7 offset:12288
ds_read_b128 v[128:131], v4 offset:16384
ds_read_b128 v[132:135], v5 offset:16384
ds_read_b128 v[136:139], v6 offset:16384
ds_read_b128 v[140:143], v7 offset:16384
ds_read_b128 v[144:147], v4 offset:20480
ds_read_b128 v[148:151], v5 offset:20480
ds_read_b128 v[152:155], v6 offset:20480
ds_read_b128 v[156:159], v7 offset:20480
ds_read_b128 v[160:163], v4 offset:24576
ds_read_b128 v[164:167], v5 offset:24576
ds_read_b128 v[168:171], v6 offset:24576
ds_read_b128 v[172:175], v7 offset:24576
ds_read_b128 v[176:179], v4 offset:28672
ds_read_b128 v[180:183], v5 offset:28672
ds_read_b128 v[184:187], v6 offset:28672
ds_read_b128 v[188:191], v7 offset:28672
s_waitcnt vmcnt(0) lgkmcnt(0)
v_mfma_f32_16x16x32_bf16 v[192:195], v[64:67], v[32:35], 0
v_mfma_f32_16x16x32_bf16 v[196:199], v[80:83], v[32:35], 0
v_mfma_f32_16x16x32_bf16 v[200:203], v[96:99], v[32:35], 0
v_mfma_f32_16x16x32_bf16 v[204:207], v[112:115], v[32:35], 0
v_mfma_f32_16x16x32_bf16 v[192:195], v[68:71], v[36:39], v[192:195]
v_mfma_f32_16x16x32_bf16 v[196:199], v[84:87], v[36:39], v[196:199]
v_mfma_f32_16x16x32_bf16 v[200:203], v[100:103], v[36:39], v[200:203]
v_mfma_f32_16x16x32_bf16 v[204:207], v[116:119], v[36:39], v[204:207]
v_mfma_f32_16x16x32_bf16 v[192:195], v[72:75], v[40:43], v[192:195]
v_mfma_f32_16x16x32_bf16 v[196:199], v[88:91], v[40:43], v[196:199]
v_mfma_f32_16x16x32_bf16 v[200:203], v[104:107], v[40:43], v[200:203]
v_mfma_f32_16x16x32_bf16 v[204:207], v[120:123], v[40:43], v[204:207]
v_mfma_f32_16x16x32_bf16 v[192:195], v[76:79], v[44:47], v[192:195]
v_mfma_f32_16x16x32_bf16 v[196:199], v[92:95], v[44:47], v[196:199]
v_mfma_f32_16x16x32_bf16 v[200:203], v[108:111], v[44:47], v[200:203]
v_mfma_f32_16x16x32_bf16 v[204:207], v[124:127], v[44:47], v[204:207]
v_mfma_f32_16x16x32_bf16 v[192:195], v[128:131], v[48:51], v[192:195]
v_mfma_f32_16x16x32_bf16 v[196:199], v[144:147], v[48:51], v[196:199]
v_mfma_f32_16x16x32_bf16 v[200:203], v[160:163], v[48:51], v[200:203]
v_mfma_f32_16x16x32_bf16 v[204:207], v[176:179], v[48:51], v[204:207]
v_mfma_f32_16x16x32_bf16 v[192:195], v[132:135], v[52:55], v[192:195]
v_mfma_f32_16x16x32_bf16 v[196:199], v[148:151], v[52:55], v[196:199]
v_mfma_f32_16x16x32_bf16 v[200:203], v[164:167], v[52:55], v[200:203]
v_mfma_f32_16x16x32_bf16 v[204:207], v[180:183], v[52:55], v[204:207]
v_mfma_f32_16x16x32_bf16 v[192:195], v[136:139], v[56:59], v[192:195]
v_mfma_f32_16x16x32_bf16 v[196:199], v[152:155], v[56:59], v[196:199]
v_mfma_f32_16x16x32_bf16 v[200:203], v[168:171], v[56:59], v[200:203]
v_mfma_f32_16x16x32_bf16 v[204:207], v[184:187], v[56:59], v[204:207]
v_mfma_f32_16x16x32_bf16 v[192:195], v[140:143], v[60:63], v[192:195]
v_mfma_f32_16x16x32_bf16 v[196:199], v[156:159], v[60:63], v[196:199]
v_mfma_f32_16x16x32_bf16 v[200:203], v[172:175], v[60:63], v[200:203]
v_mfma_f32_16x16x32_bf16 v[204:207], v[188:191], v[60:63], v[204:207]
s_lshl_b32 s16, s27, 12
s_add_u32 s16, s16, 131072
v_add_u32 v17, s16, v12
s_nop 7
ds_write_b128 v17, v[192:195] offset:0
ds_write_b128 v17, v[196:199] offset:1024
ds_write_b128 v17, v[200:203] offset:2048
ds_write_b128 v17, v[204:207] offset:3072
s_waitcnt lgkmcnt(0)
s_mov_b64 exec, 1
ds_add_u32 v30, v31 offset:8
s_mov_b64 exec, -1
v_add_u32 v52, 0, v3
v_xor_b32 v52, v52, v2
v_lshlrev_b32 v52, 4, v52
v_lshl_add_u32 v52, v2, 8, v52
v_add_u32 v52, s33, v52
v_add_u32 v53, 4, v3
v_xor_b32 v53, v53, v2
v_lshlrev_b32 v53, 4, v53
v_lshl_add_u32 v53, v2, 8, v53
v_add_u32 v53, s33, v53
v_add_u32 v54, 8, v3
v_xor_b32 v54, v54, v2
v_lshlrev_b32 v54, 4, v54
v_lshl_add_u32 v54, v2, 8, v54
v_add_u32 v54, s33, v54
v_add_u32 v55, 12, v3
v_xor_b32 v55, v55, v2
v_lshlrev_b32 v55, 4, v55
v_lshl_add_u32 v55, v2, 8, v55
v_add_u32 v55, s33, v55
v_xor_b32 v60, v2, v3
v_xor_b32 v56, 0, v60
v_lshlrev_b32 v56, 4, v56
v_lshl_add_u32 v56, v3, 8, v56
v_add_u32 v56, s33, v56
v_xor_b32 v57, 4, v60
v_lshlrev_b32 v57, 4, v57
v_lshl_add_u32 v57, v3, 8, v57
v_add_u32 v57, s33, v57
v_xor_b32 v58, 8, v60
v_lshlrev_b32 v58, 4, v58
v_lshl_add_u32 v58, v3, 8, v58
v_add_u32 v58, s33, v58
v_xor_b32 v59, 12, v60
v_lshlrev_b32 v59, 4, v59
v_lshl_add_u32 v59, v3, 8, v59
v_add_u32 v59, s33, v59
ds_read_b64_tr_b16 v[64:65], v20 offset:0
ds_read_b64_tr_b16 v[66:67], v20 offset:4096
ds_read_b64_tr_b16 v[68:69], v20 offset:8192
ds_read_b64_tr_b16 v[70:71], v20 offset:12288
ds_read_b64_tr_b16 v[72:73], v21 offset:0
ds_read_b64_tr_b16 v[74:75], v21 offset:4096
ds_read_b64_tr_b16 v[76:77], v21 offset:8192
ds_read_b64_tr_b16 v[78:79], v21 offset:12288
ds_read_b64_tr_b16 v[80:81], v22 offset:0
ds_read_b64_tr_b16 v[82:83], v22 offset:4096
ds_read_b64_tr_b16 v[84:85], v22 offset:8192
ds_read_b64_tr_b16 v[86:87], v22 offset:12288
ds_read_b64_tr_b16 v[88:89], v23 offset:0
ds_read_b64_tr_b16 v[90:91], v23 offset:4096
ds_read_b64_tr_b16 v[92:93], v23 offset:8192
ds_read_b64_tr_b16 v[94:95], v23 offset:12288
ds_read_b64_tr_b16 v[96:97], v24 offset:0
ds_read_b64_tr_b16 v[98:99], v24 offset:4096
ds_read_b64_tr_b16 v[100:101], v24 offset:8192
ds_read_b64_tr_b16 v[102:103], v24 offset:12288
ds_read_b64_tr_b16 v[104:105], v25 offset:0
ds_read_b64_tr_b16 v[106:107], v25 offset:4096
ds_read_b64_tr_b16 v[108:109], v25 offset:8192
ds_read_b64_tr_b16 v[110:111], v25 offset:12288
ds_read_b64_tr_b16 v[112:113], v26 offset:0
ds_read_b64_tr_b16 v[114:115], v26 offset:4096
ds_read_b64_tr_b16 v[116:117], v26 offset:8192
ds_read_b64_tr_b16 v[118:119], v26 offset:12288
ds_read_b64_tr_b16 v[120:121], v27 offset:0
ds_read_b64_tr_b16 v[122:123], v27 offset:4096
ds_read_b64_tr_b16 v[124:125], v27 offset:8192
ds_read_b64_tr_b16 v[126:127], v27 offset:12288
ds_read_b64_tr_b16 v[128:129], v20 offset:16384
ds_read_b64_tr_b16 v[130:131], v20 offset:20480
ds_read_b64_tr_b16 v[132:133], v20 offset:24576
ds_read_b64_tr_b16 v[134:135], v20 offset:28672
ds_read_b64_tr_b16 v[136:137], v21 offset:16384
ds_read_b64_tr_b16 v[138:139], v21 offset:20480
ds_read_b64_tr_b16 v[140:141], v21 offset:24576
ds_read_b64_tr_b16 v[142:143], v21 offset:28672
ds_read_b64_tr_b16 v[144:145], v22 offset:16384
ds_read_b64_tr_b16 v[146:147], v22 offset:20480
ds_read_b64_tr_b16 v[148:149], v22 offset:24576
ds_read_b64_tr_b16 v[150:151], v22 offset:28672
ds_read_b64_tr_b16 v[152:153], v23 offset:16384
ds_read_b64_tr_b16 v[154:155], v23 offset:20480
ds_read_b64_tr_b16 v[156:157], v23 offset:24576
ds_read_b64_tr_b16 v[158:159], v23 offset:28672
ds_read_b64_tr_b16 v[160:161], v24 offset:16384
ds_read_b64_tr_b16 v[162:163], v24 offset:20480
ds_read_b64_tr_b16 v[164:165], v24 offset:24576
ds_read_b64_tr_b16 v[166:167], v24 offset:28672
ds_read_b64_tr_b16 v[168:169], v25 offset:16384
ds_read_b64_tr_b16 v[170:171], v25 offset:20480
ds_read_b64_tr_b16 v[172:173], v25 offset:24576
ds_read_b64_tr_b16 v[174:175], v25 offset:28672
ds_read_b64_tr_b16 v[176:177], v26 offset:16384
ds_read_b64_tr_b16 v[178:179], v26 offset:20480
ds_read_b64_tr_b16 v[180:181], v26 offset:24576
ds_read_b64_tr_b16 v[182:183], v26 offset:28672
ds_read_b64_tr_b16 v[184:185], v27 offset:16384
ds_read_b64_tr_b16 v[186:187], v27 offset:20480
ds_read_b64_tr_b16 v[188:189], v27 offset:24576
ds_read_b64_tr_b16 v[190:191], v27 offset:28672
s_mov_b32 s24, 2000000
L_w_14:
ds_read_b32 v29, v30 offset:8
s_waitcnt lgkmcnt(0)
v_readfirstlane_b32 s17, v29
s_sub_u32 s24, s24, 1
s_cmp_eq_u32 s24, 0
s_cbranch_scc1 L_wd_15
s_cmp_ge_u32 s17, 4
s_cbranch_scc1 L_wd_15
s_branch L_w_14
L_wd_15:
v_add_u32 v17, 131072, v12
ds_read_b128 v[192:195], v17 offset:0
ds_read_b128 v[196:199], v17 offset:1024
ds_read_b128 v[200:203], v17 offset:2048
ds_read_b128 v[204:207], v17 offset:3072
ds_read_b128 v[208:211], v17 offset:4096
ds_read_b128 v[212:215], v17 offset:5120
ds_read_b128 v[216:219], v17 offset:6144
ds_read_b128 v[220:223], v17 offset:7168
ds_read_b128 v[224:227], v17 offset:8192
ds_read_b128 v[228:231], v17 offset:9216
ds_read_b128 v[232:235], v17 offset:10240
ds_read_b128 v[236:239], v17 offset:11264
ds_read_b128 v[240:243], v17 offset:12288
ds_read_b128 v[244:247], v17 offset:13312
ds_read_b128 v[248:251], v17 offset:14336
ds_read_b128 v[252:255], v17 offset:15360
s_waitcnt lgkmcnt(0)
v_pk_add_f32 v[192:193], v[192:193], v[208:209]
v_pk_add_f32 v[224:225], v[224:225], v[240:241]
v_pk_add_f32 v[194:195], v[194:195], v[210:211]
v_pk_add_f32 v[226:227], v[226:227], v[242:243]
v_pk_add_f32 v[196:197], v[196:197], v[212:213]
v_pk_add_f32 v[228:229], v[228:229], v[244:245]
v_pk_add_f32 v[198:199], v[198:199], v[214:215]
v_pk_add_f32 v[230:231], v[230:231], v[246:247]
v_pk_add_f32 v[200:201], v[200:201], v[216:217]
v_pk_add_f32 v[232:233], v[232:233], v[248:249]
v_pk_add_f32 v[202:203], v[202:203], v[218:219]
v_pk_add_f32 v[234:235], v[234:235], v[250:251]
v_pk_add_f32 v[204:205], v[204:205], v[220:221]
v_pk_add_f32 v[236:237], v[236:237], v[252:253]
v_pk_add_f32 v[206:207], v[206:207], v[222:223]
v_pk_add_f32 v[238:239], v[238:239], v[254:255]
v_pk_add_f32 v[192:193], v[192:193], v[224:225]
v_pk_add_f32 v[194:195], v[194:195], v[226:227]
v_pk_add_f32 v[196:197], v[196:197], v[228:229]
v_pk_add_f32 v[198:199], v[198:199], v[230:231]
v_pk_add_f32 v[200:201], v[200:201], v[232:233]
v_pk_add_f32 v[202:203], v[202:203], v[234:235]
v_pk_add_f32 v[204:205], v[204:205], v[236:237]
v_pk_add_f32 v[206:207], v[206:207], v[238:239]
v_max3_f32 v48, v192, v193, v194
v_max3_f32 v48, v48, v195, v196
v_max3_f32 v48, v48, v197, v198
v_max3_f32 v48, v48, v199, v200
v_max3_f32 v48, v48, v201, v202
v_max3_f32 v48, v48, v203, v204
v_max3_f32 v48, v48, v205, v206
v_max_f32 v48, v48, v207
v_mov_b32 v49, v48
s_nop 1
v_permlane32_swap_b32 v48, v49
v_max_f32 v48, v48, v49
v_mov_b32 v49, v48
s_nop 1
v_permlane16_swap_b32 v48, v49
v_max_f32 v48, v48, v49
v_sub_f32 v192, v192, v48
v_sub_f32 v193, v193, v48
v_sub_f32 v194, v194, v48
v_sub_f32 v195, v195, v48
v_sub_f32 v196, v196, v48
v_sub_f32 v197, v197, v48
v_sub_f32 v198, v198, v48
v_sub_f32 v199, v199, v48
v_sub_f32 v200, v200, v48
v_sub_f32 v201, v201, v48
v_sub_f32 v202, v202, v48
v_sub_f32 v203, v203, v48
v_sub_f32 v204, v204, v48
v_sub_f32 v205, v205, v48
v_sub_f32 v206, v206, v48
v_sub_f32 v207, v207, v48
v_exp_f32 v192, v192
v_exp_f32 v193, v193
v_exp_f32 v194, v194
v_exp_f32 v195, v195
v_exp_f32 v196, v196
v_exp_f32 v197, v197
v_exp_f32 v198, v198
v_exp_f32 v199, v199
v_exp_f32 v200, v200
v_exp_f32 v201, v201
v_exp_f32 v202, v202
v_exp_f32 v203, v203
v_exp_f32 v204, v204
v_exp_f32 v205, v205
v_exp_f32 v206, v206
v_exp_f32 v207, v207
s_nop 0
v_cvt_pk_bf16_f32 v32, v192, v193
v_cvt_pk_bf16_f32 v33, v194, v195
v_cvt_pk_bf16_f32 v34, v196, v197
v_cvt_pk_bf16_f32 v35, v198, v199
v_cvt_pk_bf16_f32 v36, v200, v201
v_cvt_pk_bf16_f32 v37, v202, v203
v_cvt_pk_bf16_f32 v38, v204, v205
v_cvt_pk_bf16_f32 v39, v206, v207
v_add_f32 v49, v192, v193
v_add_f32 v49, v49, v194
v_add_f32 v49, v49, v195
v_add_f32 v49, v49, v196
v_add_f32 v49, v49, v197
v_add_f32 v49, v49, v198
v_add_f32 v49, v49, v199
v_add_f32 v49, v49, v200
v_add_f32 v49, v49, v201
v_add_f32 v49, v49, v202
v_add_f32 v49, v49, v203
v_add_f32 v49, v49, v204
v_add_f32 v49, v49, v205
v_add_f32 v49, v49, v206
v_add_f32 v49, v49, v207
s_nop 1
v_mfma_f32_16x16x32_bf16 v[192:195], v[64:67], v[32:35], 0
v_mfma_f32_16x16x32_bf16 v[196:199], v[72:75], v[32:35], 0
v_mfma_f32_16x16x32_bf16 v[200:203], v[80:83], v[32:35], 0
v_mfma_f32_16x16x32_bf16 v[204:207], v[88:91], v[32:35], 0
v_mfma_f32_16x16x32_bf16 v[208:211], v[96:99], v[32:35], 0
v_mfma_f32_16x16x32_bf16 v[212:215], v[104:107], v[32:35], 0
v_mfma_f32_16x16x32_bf16 v[216:219], v[112:115], v[32:35], 0
v_mfma_f32_16x16x32_bf16 v[220:223], v[120:123], v[32:35], 0
v_mfma_f32_16x16x32_bf16 v[192:195], v[68:71], v[36:39], v[192:195]
v_mfma_f32_16x16x32_bf16 v[196:199], v[76:79], v[36:39], v[196:199]
v_mfma_f32_16x16x32_bf16 v[200:203], v[84:87], v[36:39], v[200:203]
v_mfma_f32_16x16x32_bf16 v[204:207], v[92:95], v[36:39], v[204:207]
v_mfma_f32_16x16x32_bf16 v[208:211], v[100:103], v[36:39], v[208:211]
v_mfma_f32_16x16x32_bf16 v[212:215], v[108:111], v[36:39], v[212:215]
v_mfma_f32_16x16x32_bf16 v[216:219], v[116:119], v[36:39], v[216:219]
v_mfma_f32_16x16x32_bf16 v[220:223], v[124:127], v[36:39], v[220:223]
v_mfma_f32_16x16x32_bf16 v[224:227], v[128:131], v[32:35], 0
v_mfma_f32_16x16x32_bf16 v[228:231], v[136:139], v[32:35], 0
v_mfma_f32_16x16x32_bf16 v[232:235], v[144:147], v[32:35], 0
v_mfma_f32_16x16x32_bf16 v[236:239], v[152:155], v[32:35], 0
v_mfma_f32_16x16x32_bf16 v[240:243], v[160:163], v[32:35], 0
v_mfma_f32_16x16x32_bf16 v[244:247], v[168:171], v[32:35], 0
v_mfma_f32_16x16x32_bf16 v[248:251], v[176:179], v[32:35], 0
v_mfma_f32_16x16x32_bf16 v[252:255], v[184:187], v[32:35], 0
v_mfma_f32_16x16x32_bf16 v[224:227], v[132:135], v[36:39], v[224:227]
v_mfma_f32_16x16x32_bf16 v[228:231], v[140:143], v[36:39], v[228:231]
v_mfma_f32_16x16x32_bf16 v[232:235], v[148:151], v[36:39], v[232:235]
v_mfma_f32_16x16x32_bf16 v[236:239], v[156:159], v[36:39], v[236:239]
v_mfma_f32_16x16x32_bf16 v[240:243], v[164:167], v[36:39], v[240:243]
v_mfma_f32_16x16x32_bf16 v[244:247], v[172:175], v[36:39], v[244:247]
v_mfma_f32_16x16x32_bf16 v[248:251], v[180:183], v[36:39], v[248:251]
v_mfma_f32_16x16x32_bf16 v[252:255], v[188:191], v[36:39], v[252:255]
s_mov_b64 exec, 1
ds_add_u32 v30, v31 offset:28
s_mov_b64 exec, -1
v_mov_b32 v50, v49
s_nop 1
v_permlane32_swap_b32 v49, v50
v_add_f32 v49, v49, v50
v_mov_b32 v50, v49
s_nop 1
v_permlane16_swap_b32 v49, v50
v_add_f32 v49, v49, v50
s_mov_b32 s16, 327680
v_mul_lo_u32 v17, v2, s16
v_lshl_add_u32 v18, v3, 4, v17
v_mul_lo_u32 v19, v3, s16
v_add_u32 v19, v19, v14
s_lshl_b32 s16, s4, 7
s_lshl_b32 s17, s27, 1
s_add_u32 s16, s16, s17
s_mul_i32 s16, s16, 40960
s_add_u32 s16, s16, 1048576
s_lshl_b32 s17, s9, 8
s_add_u32 s25, s16, s17
v_cvt_pk_bf16_f32 v64, v192, v193
v_cvt_pk_bf16_f32 v65, v194, v195
v_cvt_pk_bf16_f32 v66, v196, v197
v_cvt_pk_bf16_f32 v67, v198, v199
ds_write_b128 v52, v[64:67] offset:0
v_cvt_pk_bf16_f32 v68, v200, v201
v_cvt_pk_bf16_f32 v69, v202, v203
v_cvt_pk_bf16_f32 v70, v204, v205
v_cvt_pk_bf16_f32 v71, v206, v207
ds_write_b128 v53, v[68:71] offset:0
v_cvt_pk_bf16_f32 v72, v208, v209
v_cvt_pk_bf16_f32 v73, v210, v211
v_cvt_pk_bf16_f32 v74, v212, v213
v_cvt_pk_bf16_f32 v75, v214, v215
ds_write_b128 v54, v[72:75] offset:0
v_cvt_pk_bf16_f32 v76, v216, v217
v_cvt_pk_bf16_f32 v77, v218, v219
v_cvt_pk_bf16_f32 v78, v220, v221
v_cvt_pk_bf16_f32 v79, v222, v223
ds_write_b128 v55, v[76:79] offset:0
v_cvt_pk_bf16_f32 v80, v224, v225
v_cvt_pk_bf16_f32 v81, v226, v227
v_cvt_pk_bf16_f32 v82, v228, v229
v_cvt_pk_bf16_f32 v83, v230, v231
ds_write_b128 v52, v[80:83] offset:4096
v_cvt_pk_bf16_f32 v84, v232, v233
v_cvt_pk_bf16_f32 v85, v234, v235
v_cvt_pk_bf16_f32 v86, v236, v237
v_cvt_pk_bf16_f32 v87, v238, v239
ds_write_b128 v53, v[84:87] offset:4096
v_cvt_pk_bf16_f32 v88, v240, v241
v_cvt_pk_bf16_f32 v89, v242, v243
v_cvt_pk_bf16_f32 v90, v244, v245
v_cvt_pk_bf16_f32 v91, v246, v247
ds_write_b128 v54, v[88:91] offset:4096
v_cvt_pk_bf16_f32 v92, v248, v249
v_cvt_pk_bf16_f32 v93, v250, v251
v_cvt_pk_bf16_f32 v94, v252, v253
v_cvt_pk_bf16_f32 v95, v254, v255
ds_write_b128 v55, v[92:95] offset:4096
s_waitcnt lgkmcnt(0)
ds_read_b128 v[96:99], v56 offset:0
ds_read_b128 v[100:103], v57 offset:1024
ds_read_b128 v[104:107], v58 offset:2048
ds_read_b128 v[108:111], v59 offset:3072
ds_read_b128 v[112:115], v56 offset:4096
ds_read_b128 v[116:119], v57 offset:5120
ds_read_b128 v[120:123], v58 offset:6144
ds_read_b128 v[124:127], v59 offset:7168
s_add_u32 s17, s25, 0
s_waitcnt lgkmcnt(7)
buffer_store_dwordx4 v[96:99], v19, s[12:15], s17 offen sc1
s_add_u32 s17, s25, 1310720
s_waitcnt lgkmcnt(6)
buffer_store_dwordx4 v[100:103], v19, s[12:15], s17 offen sc1
s_add_u32 s17, s25, 2621440
s_waitcnt lgkmcnt(5)
buffer_store_dwordx4 v[104:107], v19, s[12:15], s17 offen sc1
s_add_u32 s17, s25, 3932160
s_waitcnt lgkmcnt(4)
buffer_store_dwordx4 v[108:111], v19, s[12:15], s17 offen sc1
s_add_u32 s17, s25, 40960
s_waitcnt lgkmcnt(3)
buffer_store_dwordx4 v[112:115], v19, s[12:15], s17 offen sc1
s_add_u32 s17, s25, 1351680
s_waitcnt lgkmcnt(2)
buffer_store_dwordx4 v[116:119], v19, s[12:15], s17 offen sc1
s_add_u32 s17, s25, 2662400
s_waitcnt lgkmcnt(1)
buffer_store_dwordx4 v[120:123], v19, s[12:15], s17 offen sc1
s_add_u32 s17, s25, 3973120
s_waitcnt lgkmcnt(0)
buffer_store_dwordx4 v[124:127], v19, s[12:15], s17 offen sc1
s_mov_b32 s17, 40960
v_mul_lo_u32 v16, v3, s17
v_add_u32 v17, v17, v16
s_lshl_b32 s17, s9, 4
s_add_u32 s16, s16, s17
s_add_u32 s16, s16, 36864
v_mov_b32 v50, s11
v_mov_b32 v51, 0
s_waitcnt vmcnt(0)
s_mov_b32 exec_hi, 0
buffer_store_dwordx4 v[48:51], v17, s[12:15], s16 offen sc1
s_mov_b64 exec, -1
s_mov_b64 exec, 1
ds_add_u32 v30, v31 offset:36
s_mov_b64 exec, -1
s_branch L_fin
L_G1:
s_setprio 3
s_xor_b32 s5, s5, 1
s_xor_b32 s18, s18, 1
s_xor_b32 s9, s9, 8
s_xor_b32 s21, s21, 512
s_lshl_b32 s19, s4, 7
s_add_u32 s19, s19, s9
s_mul_i32 s19, s19, 40960
s_add_u32 s19, s19, 1048576
s_mul_i32 s20, s4, 56
s_add_u32 s20, s20, s9
s_lshl_b32 s20, s20, 13
s_add_u32 s20, s20, 20971520
v_lshrrev_b32 v13, 3, v2
v_mul_u32_u24 v13, 896, v13
v_mad_u32_u24 v13, v3, 56, v13
s_mul_i32 s16, s27, 224
buffer_load_dwordx4 v[32:35], v13, s[36:39], s16 offen offset:0
buffer_load_dwordx4 v[36:39], v13, s[36:39], s16 offen offset:16
buffer_load_dwordx4 v[40:43], v13, s[36:39], s16 offen offset:32
buffer_load_dwordx2 v[44:45], v13, s[36:39], s16 offen offset:48
v_lshrrev_b32 v19, 2, v2
v_mad_u32_u24 v19, v3, 28, v19
v_lshlrev_b32 v19, 13, v19
v_and_b32 v16, 3, v2
v_lshl_add_u32 v19, v16, 4, v19
s_mul_i32 s16, s27, 917504
s_xor_b32 s17, s21, 0
s_add_u32 s16, s16, s17
s_lshl_b32 s17, s6, 6
s_add_u32 s16, s16, s17
buffer_load_dwordx4 v[48:51], v19, s[44:47], s16 offen nt
s_add_u32 s16, s16, 32768
buffer_load_dwordx4 v[52:55], v19, s[44:47], s16 offen nt
s_add_u32 s16, s16, 32768
buffer_load_dwordx4 v[56:59], v19, s[44:47], s16 offen nt
s_add_u32 s16, s16, 32768
buffer_load_dwordx4 v[60:63], v19, s[44:47], s16 offen nt
s_add_u32 s16, s16, 32768
buffer_load_dwordx4 v[64:67], v19, s[44:47], s16 offen nt
s_add_u32 s16, s16, 32768
buffer_load_dwordx4 v[68:71], v19, s[44:47], s16 offen nt
s_add_u32 s16, s16, 32768
buffer_load_dwordx4 v[72:75], v19, s[44:47], s16 offen nt
s_barrier
v_and_b32 v17, 1, v2
v_bfe_u32 v18, v2, 1, 2
v_cmp_eq_u32 vcc, 1, v17
v_mov_b32 v24, 0x0c0c0100
v_mov_b32 v25, 0x01000c0c
v_cndmask_b32 v26, v24, v25, vcc
v_mov_b32 v24, 0x0c0c0302
v_mov_b32 v25, 0x03020c0c
v_cndmask_b32 v27, v24, v25, vcc
v_mov_b32 v24, 0x0c0c0c0c
v_cmp_eq_u32 vcc, 0, v18
s_nop 1
v_cndmask_b32 v4, v24, v26, vcc
v_cndmask_b32 v8, v24, v27, vcc
v_cmp_eq_u32 vcc, 1, v18
s_nop 1
v_cndmask_b32 v5, v24, v26, vcc
v_cndmask_b32 v9, v24, v27, vcc
v_cmp_eq_u32 vcc, 2, v18
s_nop 1
v_cndmask_b32 v6, v24, v26, vcc
v_cndmask_b32 v10, v24, v27, vcc
v_cmp_eq_u32 vcc, 3, v18
s_nop 1
v_cndmask_b32 v7, v24, v26, vcc
v_cndmask_b32 v11, v24, v27, vcc
s_waitcnt lgkmcnt(0)
s_mul_i32 s11, s11, 0x9E3779B1
s_add_u32 s11, s11, 0x7F4A7C15
s_mov_b32 s34, s11
s_mov_b32 s35, s11
s_waitcnt vmcnt(6)
v_perm_b32 v192, v32, v32, v4
v_perm_b32 v193, v32, v32, v5
v_perm_b32 v194, v32, v32, v6
v_perm_b32 v195, v32, v32, v7
v_perm_b32 v196, v32, v32, v8
v_perm_b32 v197, v32, v32, v9
v_perm_b32 v198, v32, v32, v10
v_perm_b32 v199, v32, v32, v11
v_mfma_f32_16x16x32_bf16 v[176:179], v[192:195], v[48:51], 0
v_perm_b32 v192, v33, v33, v4
v_perm_b32 v193, v33, v33, v5
v_perm_b32 v194, v33, v33, v6
v_perm_b32 v195, v33, v33, v7
v_mfma_f32_16x16x32_bf16 v[180:183], v[196:199], v[48:51], 0
v_perm_b32 v196, v33, v33, v8
v_perm_b32 v197, v33, v33, v9
v_perm_b32 v198, v33, v33, v10
v_perm_b32 v199, v33, v33, v11
v_mfma_f32_16x16x32_bf16 v[184:187], v[192:195], v[48:51], 0
v_perm_b32 v192, v34, v34, v4
v_perm_b32 v193, v34, v34, v5
v_perm_b32 v194, v34, v34, v6
v_perm_b32 v195, v34, v34, v7
v_mfma_f32_16x16x32_bf16 v[188:191], v[196:199], v[48:51], 0
v_perm_b32 v196, v34, v34, v8
v_perm_b32 v197, v34, v34, v9
v_perm_b32 v198, v34, v34, v10
v_perm_b32 v199, v34, v34, v11
s_waitcnt vmcnt(5)
v_mfma_f32_16x16x32_bf16 v[176:179], v[192:195], v[52:55], v[176:179]
v_perm_b32 v192, v35, v35, v4
v_perm_b32 v193, v35, v35, v5
v_perm_b32 v194, v35, v35, v6
v_perm_b32 v195, v35, v35, v7
v_mfma_f32_16x16x32_bf16 v[180:183], v[196:199], v[52:55], v[180:183]
v_perm_b32 v196, v35, v35, v8
v_perm_b32 v197, v35, v35, v9
v_perm_b32 v198, v35, v35, v10
v_perm_b32 v199, v35, v35, v11
v_mfma_f32_16x16x32_bf16 v[184:187], v[192:195], v[52:55], v[184:187]
v_perm_b32 v192, v36, v36, v4
v_perm_b32 v193, v36, v36, v5
v_perm_b32 v194, v36, v36, v6
v_perm_b32 v195, v36, v36, v7
v_mfma_f32_16x16x32_bf16 v[188:191], v[196:199], v[52:55], v[188:191]
v_perm_b32 v196, v36, v36, v8
v_perm_b32 v197, v36, v36, v9
v_perm_b32 v198, v36, v36, v10
v_perm_b32 v199, v36, v36, v11
s_waitcnt vmcnt(4)
v_mfma_f32_16x16x32_bf16 v[176:179], v[192:195], v[56:59], v[176:179]
v_perm_b32 v192, v37, v37, v4
v_perm_b32 v193, v37, v37, v5
v_perm_b32 v194, v37, v37, v6
v_perm_b32 v195, v37, v37, v7
v_mfma_f32_16x16x32_bf16 v[180:183], v[196:199], v[56:59], v[180:183]
v_perm_b32 v196, v37, v37, v8
v_perm_b32 v197, v37, v37, v9
v_perm_b32 v198, v37, v37, v10
v_perm_b32 v199, v37, v37, v11
v_mfma_f32_16x16x32_bf16 v[184:187], v[192:195], v[56:59], v[184:187]
v_perm_b32 v192, v38, v38, v4
v_perm_b32 v193, v38, v38, v5
v_perm_b32 v194, v38, v38, v6
v_perm_b32 v195, v38, v38, v7
v_mfma_f32_16x16x32_bf16 v[188:191], v[196:199], v[56:59], v[188:191]
v_perm_b32 v196, v38, v38, v8
v_perm_b32 v197, v38, v38, v9
v_perm_b32 v198, v38, v38, v10
v_perm_b32 v199, v38, v38, v11
s_waitcnt vmcnt(3)
v_mfma_f32_16x16x32_bf16 v[176:179], v[192:195], v[60:63], v[176:179]
v_perm_b32 v192, v39, v39, v4
v_perm_b32 v193, v39, v39, v5
v_perm_b32 v194, v39, v39, v6
v_perm_b32 v195, v39, v39, v7
v_mfma_f32_16x16x32_bf16 v[180:183], v[196:199], v[60:63], v[180:183]
v_perm_b32 v196, v39, v39, v8
v_perm_b32 v197, v39, v39, v9
v_perm_b32 v198, v39, v39, v10
v_perm_b32 v199, v39, v39, v11
v_mfma_f32_16x16x32_bf16 v[184:187], v[192:195], v[60:63], v[184:187]
v_perm_b32 v192, v40, v40, v4
v_perm_b32 v193, v40, v40, v5
v_perm_b32 v194, v40, v40, v6
v_perm_b32 v195, v40, v40, v7
v_mfma_f32_16x16x32_bf16 v[188:191], v[196:199], v[60:63], v[188:191]
v_perm_b32 v196, v40, v40, v8
v_perm_b32 v197, v40, v40, v9
v_perm_b32 v198, v40, v40, v10
v_perm_b32 v199, v40, v40, v11
s_waitcnt vmcnt(2)
v_mfma_f32_16x16x32_bf16 v[176:179], v[192:195], v[64:67], v[176:179]
v_perm_b32 v192, v41, v41, v4
v_perm_b32 v193, v41, v41, v5
v_perm_b32 v194, v41, v41, v6
v_perm_b32 v195, v41, v41, v7
v_mfma_f32_16x16x32_bf16 v[180:183], v[196:199], v[64:67], v[180:183]
v_perm_b32 v196, v41, v41, v8
v_perm_b32 v197, v41, v41, v9
v_perm_b32 v198, v41, v41, v10
v_perm_b32 v199, v41, v41, v11
v_mfma_f32_16x16x32_bf16 v[184:187], v[192:195], v[64:67], v[184:187]
v_perm_b32 v192, v42, v42, v4
v_perm_b32 v193, v42, v42, v5
v_perm_b32 v194, v42, v42, v6
v_perm_b32 v195, v42, v42, v7
v_mfma_f32_16x16x32_bf16 v[188:191], v[196:199], v[64:67], v[188:191]
v_perm_b32 v196, v42, v42, v8
v_perm_b32 v197, v42, v42, v9
v_perm_b32 v198, v42, v42, v10
v_perm_b32 v199, v42, v42, v11
s_waitcnt vmcnt(1)
v_mfma_f32_16x16x32_bf16 v[176:179], v[192:195], v[68:71], v[176:179]
v_perm_b32 v192, v43, v43, v4
v_perm_b32 v193, v43, v43, v5
v_perm_b32 v194, v43, v43, v6
v_perm_b32 v195, v43, v43, v7
v_mfma_f32_16x16x32_bf16 v[180:183], v[196:199], v[68:71], v[180:183]
v_perm_b32 v196, v43, v43, v8
v_perm_b32 v197, v43, v43, v9
v_perm_b32 v198, v43, v43, v10
v_perm_b32 v199, v43, v43, v11
v_mfma_f32_16x16x32_bf16 v[184:187], v[192:195], v[68:71], v[184:187]
v_perm_b32 v192, v44, v44, v4
v_perm_b32 v193, v44, v44, v5
v_perm_b32 v194, v44, v44, v6
v_perm_b32 v195, v44, v44, v7
v_mfma_f32_16x16x32_bf16 v[188:191], v[196:199], v[68:71], v[188:191]
v_perm_b32 v196, v44, v44, v8
v_perm_b32 v197, v44, v44, v9
v_perm_b32 v198, v44, v44, v10
v_perm_b32 v199, v44, v44, v11
s_waitcnt vmcnt(0)
v_mfma_f32_16x16x32_bf16 v[176:179], v[192:195], v[72:75], v[176:179]
v_perm_b32 v192, v45, v45, v4
v_perm_b32 v193, v45, v45, v5
v_perm_b32 v194, v45, v45, v6
v_perm_b32 v195, v45, v45, v7
v_mfma_f32_16x16x32_bf16 v[180:183], v[196:199], v[72:75], v[180:183]
v_perm_b32 v196, v45, v45, v8
v_perm_b32 v197, v45, v45, v9
v_perm_b32 v198, v45, v45, v10
v_perm_b32 v199, v45, v45, v11
v_mfma_f32_16x16x32_bf16 v[184:187], v[192:195], v[72:75], v[184:187]
s_nop 1
v_mfma_f32_16x16x32_bf16 v[188:191], v[196:199], v[72:75], v[188:191]
v_lshrrev_b32 v17, 2, v2
s_nop 7
v_cmp_eq_u32 vcc, 1, v17
s_nop 1
v_cndmask_b32 v176, v176, v180, vcc
v_cndmask_b32 v177, v177, v181, vcc
v_cndmask_b32 v178, v178, v182, vcc
v_cndmask_b32 v179, v179, v183, vcc
v_cmp_eq_u32 vcc, 2, v17
s_nop 1
v_cndmask_b32 v176, v176, v184, vcc
v_cndmask_b32 v177, v177, v185, vcc
v_cndmask_b32 v178, v178, v186, vcc
v_cndmask_b32 v179, v179, v187, vcc
v_cmp_eq_u32 vcc, 3, v17
s_nop 1
v_cndmask_b32 v176, v176, v188, vcc
v_cndmask_b32 v177, v177, v189, vcc
v_cndmask_b32 v178, v178, v190, vcc
v_cndmask_b32 v179, v179, v191, vcc
s_nop 1
v_add_f32_dpp v176, v176, v176 row_ror:4 row_mask:0xf bank_mask:0xf
v_add_f32_dpp v177, v177, v177 row_ror:4 row_mask:0xf bank_mask:0xf
v_add_f32_dpp v178, v178, v178 row_ror:4 row_mask:0xf bank_mask:0xf
v_add_f32_dpp v179, v179, v179 row_ror:4 row_mask:0xf bank_mask:0xf
s_nop 1
v_add_f32_dpp v176, v176, v176 row_ror:8 row_mask:0xf bank_mask:0xf
v_add_f32_dpp v177, v177, v177 row_ror:8 row_mask:0xf bank_mask:0xf
v_add_f32_dpp v178, v178, v178 row_ror:8 row_mask:0xf bank_mask:0xf
v_add_f32_dpp v179, v179, v179 row_ror:8 row_mask:0xf bank_mask:0xf
s_lshl_b32 s16, s27, 8
s_add_u32 s16, s16, 149504
v_lshrrev_b32 v17, 1, v3
v_lshlrev_b32 v17, 7, v17
v_lshl_add_u32 v17, v2, 5, v17
v_and_b32 v18, 1, v3
v_lshl_add_u32 v17, v18, 4, v17
v_add_u32 v17, s16, v17
v_cmp_gt_u32 vcc, 4, v2
s_and_saveexec_b64 s[22:23], vcc
ds_write_b128 v17, v[176:179]
s_mov_b64 exec, s[22:23]
s_waitcnt lgkmcnt(0)
s_mov_b64 exec, 1
ds_add_u32 v30, v31 offset:0
s_mov_b64 exec, -1
s_cmp_lg_u32 s27, 0
s_cbranch_scc1 L_q0_16
s_mov_b32 s24, 2000000
L_w_17:
ds_read_b32 v29, v30 offset:0
s_waitcnt lgkmcnt(0)
v_readfirstlane_b32 s17, v29
s_sub_u32 s24, s24, 1
s_cmp_eq_u32 s24, 0
s_cbranch_scc1 L_wd_18
s_cmp_ge_u32 s17, 4
s_cbranch_scc1 L_wd_18
s_branch L_w_17
L_wd_18:
v_lshlrev_b32 v17, 2, v1
v_add_u32 v17, 149504, v17
ds_read_b32 v32, v17 offset:0
ds_read_b32 v33, v17 offset:256
ds_read_b32 v34, v17 offset:512
ds_read_b32 v35, v17 offset:768
s_waitcnt lgkmcnt(0)
v_add_f32 v32, v32, v33
v_add_f32 v34, v34, v35
v_add_f32 v32, v32, v34
v_mov_b32 v33, v32
s_nop 1
v_permlane32_swap_b32 v32, v33
s_nop 0
v_cvt_pk_bf16_f32 v34, v32, v33
v_mov_b32 v35, s11
v_lshlrev_b32 v17, 3, v1
s_xor_b32 s16, s18, 0
s_lshl_b32 s16, s16, 11
s_lshl_b32 s17, s6, 8
s_add_u32 s16, s16, s17
s_add_u32 s16, s16, 262144
s_mov_b32 exec_hi, 0
buffer_store_dwordx2 v[34:35], v17, s[12:15], s16 offen sc1
s_mov_b64 exec, -1
L_q0_16:
s_setprio 0
v_mov_b32 v40, -1
v_mov_b32 v41, -1
v_mov_b32 v42, -1
v_mov_b32 v43, -1
s_cmp_ge_u32 s27, 2
s_cbranch_scc1 L_p1_19
s_lshl_b32 s16, s27, 10
s_add_u32 s16, s16, s19
s_add_u32 s16, s16, 32768
buffer_store_dwordx4 v[40:43], v12, s[12:15], s16 offen sc1
L_p1_19:
s_cmp_ge_u32 s9, 56
s_cbranch_scc1 L_p2_20
s_lshl_b32 s16, s27, 11
s_add_u32 s16, s16, s20
buffer_store_dwordx4 v[40:43], v12, s[12:15], s16 offen sc1
buffer_store_dwordx4 v[40:43], v12, s[12:15], s16 offen offset:1024 sc1
L_p2_20:
v_add_u32 v36, 0, v3
v_xor_b32 v36, v36, v2
v_lshlrev_b32 v36, 4, v36
v_lshl_add_u32 v36, v3, 11, v36
v_add_u32 v37, 4, v3
v_xor_b32 v37, v37, v2
v_lshlrev_b32 v37, 4, v37
v_lshl_add_u32 v37, v3, 11, v37
v_add_u32 v38, 8, v3
v_xor_b32 v38, v38, v2
v_lshlrev_b32 v38, 4, v38
v_lshl_add_u32 v38, v3, 11, v38
v_add_u32 v39, 12, v3
v_xor_b32 v39, v39, v2
v_lshlrev_b32 v39, 4, v39
v_lshl_add_u32 v39, v3, 11, v39
v_lshrrev_b32 v17, 1, v3
v_and_b32 v19, 1, v3
v_xor_b32 v19, v19, v17
v_lshl_add_u32 v19, v19, 15, v14
v_lshl_add_u32 v19, v17, 18, v19
s_lshl_b32 s26, s6, 7
s_lshl_b32 s16, s27, 3
s_add_u32 s26, s26, s16
s_lshl_b32 s26, s26, 13
s_add_u32 s26, s26, s21
v_mov_b32 v17, 1792
v_mad_u32_u24 v17, v3, v17, v14
s_lshl_b32 s10, s9, 2
s_add_u32 s10, s10, s27
s_mul_i32 s10, s10, 7168
v_cmp_gt_u32 s[28:29], 8, v2
s_lshl_b32 s25, s7, 23
s_lshl_b32 s16, s8, 17
s_add_u32 s25, s25, s16
s_lshl_b32 s16, s27, 9
s_add_u32 s25, s25, s16
s_lshl_b32 s33, s27, 15
s_add_u32 s16, s33, 0
s_mov_b32 m0, s16
s_add_u32 s17, s25, 0
buffer_load_dwordx4 v36, s[40:43], s17 offen nt lds
s_add_u32 s16, s33, 16384
s_mov_b32 m0, s16
s_add_u32 s17, s25, 256
buffer_load_dwordx4 v36, s[40:43], s17 offen nt lds
s_add_u32 s16, s33, 1024
s_mov_b32 m0, s16
s_add_u32 s17, s25, 8192
buffer_load_dwordx4 v37, s[40:43], s17 offen nt lds
s_add_u32 s16, s33, 17408
s_mov_b32 m0, s16
s_add_u32 s17, s25, 8448
buffer_load_dwordx4 v37, s[40:43], s17 offen nt lds
s_waitcnt vmcnt(4)
s_mov_b64 exec, 1
ds_add_u32 v30, v31 offset:12
s_mov_b64 exec, -1
s_add_u32 s16, s33, 2048
s_mov_b32 m0, s16
s_add_u32 s17, s25, 16384
buffer_load_dwordx4 v38, s[40:43], s17 offen nt lds
s_add_u32 s16, s33, 18432
s_mov_b32 m0, s16
s_add_u32 s17, s25, 16640
buffer_load_dwordx4 v38, s[40:43], s17 offen nt lds
s_add_u32 s16, s33, 3072
s_mov_b32 m0, s16
s_add_u32 s17, s25, 24576
buffer_load_dwordx4 v39, s[40:43], s17 offen nt lds
s_add_u32 s16, s33, 19456
s_mov_b32 m0, s16
s_add_u32 s17, s25, 24832
buffer_load_dwordx4 v39, s[40:43], s17 offen nt lds
s_add_u32 s16, s33, 4096
s_mov_b32 m0, s16
s_add_u32 s17, s25, 32768
buffer_load_dwordx4 v36, s[40:43], s17 offen nt lds
s_add_u32 s16, s33, 20480
s_mov_b32 m0, s16
s_add_u32 s17, s25, 33024
buffer_load_dwordx4 v36, s[40:43], s17 offen nt lds
s_add_u32 s16, s33, 5120
s_mov_b32 m0, s16
s_add_u32 s17, s25, 40960
buffer_load_dwordx4 v37, s[40:43], s17 offen nt lds
s_add_u32 s16, s33, 21504
s_mov_b32 m0, s16
s_add_u32 s17, s25, 41216
buffer_load_dwordx4 v37, s[40:43], s17 offen nt lds
s_add_u32 s16, s33, 6144
s_mov_b32 m0, s16
s_add_u32 s17, s25, 49152
buffer_load_dwordx4 v38, s[40:43], s17 offen nt lds
s_add_u32 s16, s33, 22528
s_mov_b32 m0, s16
s_add_u32 s17, s25, 49408
buffer_load_dwordx4 v38, s[40:43], s17 offen nt lds
s_add_u32 s16, s33, 7168
s_mov_b32 m0, s16
s_add_u32 s17, s25, 57344
buffer_load_dwordx4 v39, s[40:43], s17 offen nt lds
s_add_u32 s16, s33, 23552
s_mov_b32 m0, s16
s_add_u32 s17, s25, 57600
buffer_load_dwordx4 v39, s[40:43], s17 offen nt lds
s_add_u32 s16, s33, 8192
s_mov_b32 m0, s16
s_add_u32 s17, s25, 65536
buffer_load_dwordx4 v36, s[40:43], s17 offen nt lds
s_add_u32 s16, s33, 24576
s_mov_b32 m0, s16
s_add_u32 s17, s25, 65792
buffer_load_dwordx4 v36, s[40:43], s17 offen nt lds
s_add_u32 s16, s33, 9216
s_mov_b32 m0, s16
s_add_u32 s17, s25, 73728
buffer_load_dwordx4 v37, s[40:43], s17 offen nt lds
s_add_u32 s16, s33, 25600
s_mov_b32 m0, s16
s_add_u32 s17, s25, 73984
buffer_load_dwordx4 v37, s[40:43], s17 offen nt lds
s_add_u32 s16, s33, 10240
s_mov_b32 m0, s16
s_add_u32 s17, s25, 81920
buffer_load_dwordx4 v38, s[40:43], s17 offen nt lds
s_add_u32 s16, s33, 26624
s_mov_b32 m0, s16
s_add_u32 s17, s25, 82176
buffer_load_dwordx4 v38, s[40:43], s17 offen nt lds
s_add_u32 s16, s33, 11264
s_mov_b32 m0, s16
s_add_u32 s17, s25, 90112
buffer_load_dwordx4 v39, s[40:43], s17 offen nt lds
s_add_u32 s16, s33, 27648
s_mov_b32 m0, s16
s_add_u32 s17, s25, 90368
buffer_load_dwordx4 v39, s[40:43], s17 offen nt lds
s_add_u32 s16, s33, 12288
s_mov_b32 m0, s16
s_add_u32 s17, s25, 98304
buffer_load_dwordx4 v36, s[40:43], s17 offen nt lds
s_add_u32 s16, s33, 28672
s_mov_b32 m0, s16
s_add_u32 s17, s25, 98560
buffer_load_dwordx4 v36, s[40:43], s17 offen nt lds
s_add_u32 s16, s33, 13312
s_mov_b32 m0, s16
s_add_u32 s17, s25, 106496
buffer_load_dwordx4 v37, s[40:43], s17 offen nt lds
s_add_u32 s16, s33, 29696
s_mov_b32 m0, s16
s_add_u32 s17, s25, 106752
buffer_load_dwordx4 v37, s[40:43], s17 offen nt lds
s_add_u32 s16, s33, 14336
s_mov_b32 m0, s16
s_add_u32 s17, s25, 114688
buffer_load_dwordx4 v38, s[40:43], s17 offen nt lds
s_add_u32 s16, s33, 30720
s_mov_b32 m0, s16
s_add_u32 s17, s25, 114944
buffer_load_dwordx4 v38, s[40:43], s17 offen nt lds
s_add_u32 s16, s33, 15360
s_mov_b32 m0, s16
s_add_u32 s17, s25, 122880
buffer_load_dwordx4 v39, s[40:43], s17 offen nt lds
s_add_u32 s16, s33, 31744
s_mov_b32 m0, s16
s_add_u32 s17, s25, 123136
buffer_load_dwordx4 v39, s[40:43], s17 offen nt lds
s_add_u32 s16, s26, 0
buffer_load_dwordx4 v[64:67], v19, s[52:55], s16 offen offset:0 nt
s_add_u32 s16, s26, 0
buffer_load_dwordx4 v[68:71], v19, s[52:55], s16 offen offset:256 nt
s_add_u32 s16, s26, 8192
buffer_load_dwordx4 v[72:75], v19, s[52:55], s16 offen offset:0 nt
s_add_u32 s16, s26, 8192
buffer_load_dwordx4 v[76:79], v19, s[52:55], s16 offen offset:256 nt
s_add_u32 s16, s26, 16384
buffer_load_dwordx4 v[80:83], v19, s[52:55], s16 offen offset:0 nt
s_add_u32 s16, s26, 16384
buffer_load_dwordx4 v[84:87], v19, s[52:55], s16 offen offset:256 nt
s_add_u32 s16, s26, 24576
buffer_load_dwordx4 v[88:91], v19, s[52:55], s16 offen offset:0 nt
s_add_u32 s16, s26, 24576
buffer_load_dwordx4 v[92:95], v19, s[52:55], s16 offen offset:256 nt
s_waitcnt vmcnt(8)
s_mov_b64 exec, 1
ds_add_u32 v28, v31 offset:64
s_mov_b64 exec, -1
s_add_u32 s16, s26, 524288
buffer_load_dwordx4 v[96:99], v19, s[52:55], s16 offen offset:0 nt
s_add_u32 s16, s26, 524288
buffer_load_dwordx4 v[100:103], v19, s[52:55], s16 offen offset:256 nt
s_add_u32 s16, s26, 532480
buffer_load_dwordx4 v[104:107], v19, s[52:55], s16 offen offset:0 nt
s_add_u32 s16, s26, 532480
buffer_load_dwordx4 v[108:111], v19, s[52:55], s16 offen offset:256 nt
s_add_u32 s16, s26, 540672
buffer_load_dwordx4 v[112:115], v19, s[52:55], s16 offen offset:0 nt
s_add_u32 s16, s26, 540672
buffer_load_dwordx4 v[116:119], v19, s[52:55], s16 offen offset:256 nt
s_add_u32 s16, s26, 548864
buffer_load_dwordx4 v[120:123], v19, s[52:55], s16 offen offset:0 nt
s_add_u32 s16, s26, 548864
buffer_load_dwordx4 v[124:127], v19, s[52:55], s16 offen offset:256 nt
s_add_u32 s16, s10, 0
buffer_load_dwordx4 v[128:131], v17, s[56:59], s16 offen offset:0 nt
s_add_u32 s16, s10, 0
buffer_load_dwordx4 v[132:135], v17, s[56:59], s16 offen offset:256 nt
s_add_u32 s16, s10, 0
buffer_load_dwordx4 v[136:139], v17, s[56:59], s16 offen offset:512 nt
s_add_u32 s16, s10, 0
s_mov_b64 exec, s[28:29]
buffer_load_dwordx4 v[140:143], v17, s[56:59], s16 offen offset:768 nt
s_mov_b64 exec, -1
s_add_u32 s16, s10, 896
buffer_load_dwordx4 v[144:147], v17, s[56:59], s16 offen offset:0 nt
s_add_u32 s16, s10, 896
buffer_load_dwordx4 v[148:151], v17, s[56:59], s16 offen offset:256 nt
s_add_u32 s16, s10, 896
buffer_load_dwordx4 v[152:155], v17, s[56:59], s16 offen offset:512 nt
s_add_u32 s16, s10, 896
s_mov_b64 exec, s[28:29]
buffer_load_dwordx4 v[156:159], v17, s[56:59], s16 offen offset:768 nt
s_mov_b64 exec, -1
s_setprio 2
v_lshl_add_u32 v18, v3, 11, v14
s_lshl_b32 s26, s27, 13
s_add_u32 s26, s26, s19
s_lshr_b32 s33, s27, 1
s_lshl_b32 s33, s33, 10
s_add_u32 s33, s33, s19
s_add_u32 s33, s33, 36864
s_lshl_b32 s17, s27, 8
s_add_u32 s17, s17, 148480
v_lshlrev_b32 v20, 2, v1
v_add_u32 v20, s17, v20
s_and_b32 s16, s27, 1
s_lshl_b32 s16, s16, 7
s_add_u32 s17, s17, s16
v_lshlrev_b32 v21, 5, v3
v_add_u32 v21, s17, v21
s_lshl_b32 s16, s27, 10
s_add_u32 s16, s16, 149504
v_lshrrev_b32 v22, 1, v3
v_lshlrev_b32 v22, 9, v22
v_lshl_add_u32 v22, v2, 5, v22
v_and_b32 v51, 1, v3
v_lshl_add_u32 v22, v51, 4, v22
v_add_u32 v22, s16, v22
v_lshrrev_b32 v23, 3, v2
v_lshlrev_b32 v23, 11, v23
v_lshl_add_u32 v23, v3, 4, v23
s_lshl_b32 s17, s27, 7
s_add_u32 s17, s17, 149504
v_add_u32 v23, s17, v23
s_lshl_b32 s16, s27, 11
s_add_u32 s16, s16, 153600
v_lshrrev_b32 v24, 1, v3
v_lshlrev_b32 v24, 10, v24
v_lshl_add_u32 v24, v2, 5, v24
v_and_b32 v51, 1, v3
v_lshl_add_u32 v24, v51, 4, v24
v_add_u32 v24, s16, v24
s_lshl_b32 s17, s27, 9
s_add_u32 s17, s17, 153600
v_add_u32 v25, s17, v12
v_lshrrev_b32 v26, 3, v1
s_mov_b32 s16, 40960
v_mul_lo_u32 v26, v26, s16
v_and_b32 v51, 7, v1
v_lshl_add_u32 v26, v51, 4, v26
s_mul_i32 s64, s18, 327680
s_add_u32 s64, s64, 1081344
s_lshl_b32 s17, s6, 8
s_add_u32 s64, s64, s17
s_lshr_b32 s17, s27, 1
s_lshl_b32 s17, s17, 7
s_add_u32 s64, s64, s17
s_and_b32 s17, s27, 1
s_mul_i32 s17, s17, 163840
s_add_u32 s64, s64, s17
v_lshrrev_b32 v27, 3, v2
v_lshlrev_b32 v27, 7, v27
v_lshl_add_u32 v27, v3, 3, v27
s_lshl_b32 s65, s27, 5
s_add_u32 s65, s65, s19
s_add_u32 s65, s65, 32768
s_lshl_b32 s16, s27, 12
v_lshrrev_b32 v16, 1, v3
v_lshlrev_b32 v16, 11, v16
v_lshl_add_u32 v16, v2, 5, v16
v_and_b32 v51, 1, v3
v_lshl_add_u32 v16, v51, 4, v16
v_add_u32 v16, s16, v16
v_subrev_u32 v53, 256, v0
v_cmp_le_u32 vcc, 112, v53
s_nop 1
v_cndmask_b32 v50, 0, 1, vcc
v_mul_u32_u24 v51, 112, v50
v_sub_u32 v51, v53, v51
v_lshlrev_b32 v17, 11, v50
v_lshl_add_u32 v17, v51, 4, v17
v_lshrrev_b32 v19, 2, v53
v_lshlrev_b32 v19, 13, v19
v_and_b32 v51, 3, v53
v_lshl_add_u32 v19, v51, 4, v19
s_mul_i32 s66, s4, 458752
s_lshl_b32 s17, s9, 6
s_add_u32 s66, s66, s17
s_add_u32 s66, s66, 20971520
v_cmp_gt_u32 vcc, 224, v53
s_mov_b64 s[68:69], vcc
v_cmp_lt_u32 s[70:71], 7, v2
s_lshl_b32 s67, s27, 11
s_add_u32 s67, s67, s20
s_load_dwordx2 s[60:61], s[0:1], 96
s_mov_b32 s62, 3584
s_mov_b32 s63, 0x00020000
s_mov_b32 s24, 2000000
L_w_21:
ds_read_b32 v29, v30 offset:36
s_waitcnt lgkmcnt(0)
v_readfirstlane_b32 s17, v29
s_sub_u32 s24, s24, 1
s_cmp_eq_u32 s24, 0
s_cbranch_scc1 L_wd_22
s_cmp_ge_u32 s17, 4
s_cbranch_scc1 L_wd_22
s_sleep 2
s_branch L_w_21
L_wd_22:
buffer_load_dwordx3 v[48:50], v12, s[12:15], s33 offen sc1
s_waitcnt vmcnt(0)
s_mov_b32 s24, 100000
L_st_23:
v_cmp_ne_u32 vcc, s11, v50
s_nop 1
s_cmp_eq_u64 vcc, 0
s_cbranch_scc1 L_std_24
s_sub_u32 s24, s24, 1
s_cmp_eq_u32 s24, 0
s_cbranch_scc1 L_std_24
s_sleep 2
buffer_load_dwordx3 v[48:50], v12, s[12:15], s33 offen sc1
s_waitcnt vmcnt(0)
s_branch L_st_23
L_std_24:
buffer_load_dwordx4 v[160:163], v18, s[12:15], s26 offen offset:0 sc1
buffer_load_dwordx4 v[164:167], v18, s[12:15], s26 offen offset:256 sc1
buffer_load_dwordx4 v[168:171], v18, s[12:15], s26 offen offset:512 sc1
buffer_load_dwordx4 v[172:175], v18, s[12:15], s26 offen offset:768 sc1
buffer_load_dwordx4 v[176:179], v18, s[12:15], s26 offen offset:1024 sc1
buffer_load_dwordx4 v[180:183], v18, s[12:15], s26 offen offset:1280 sc1
buffer_load_dwordx4 v[184:187], v18, s[12:15], s26 offen offset:1536 sc1
buffer_load_dwordx4 v[188:191], v18, s[12:15], s26 offen offset:1792 sc1
v_mov_b32 v50, v48
s_nop 1
v_max_f32_dpp v50, v50, v50 quad_perm:[1,0,3,2] row_mask:0xf bank_mask:0xf
s_nop 1
v_max_f32_dpp v50, v50, v50 quad_perm:[2,3,0,1] row_mask:0xf bank_mask:0xf
s_nop 1
v_max_f32_dpp v50, v50, v50 row_half_mirror row_mask:0xf bank_mask:0xf
s_nop 1
v_max_f32_dpp v50, v50, v50 row_mirror row_mask:0xf bank_mask:0xf
v_mov_b32 v51, v50
s_nop 1
v_permlane16_swap_b32 v50, v51
v_max_f32 v50, v50, v51
v_mov_b32 v51, v50
s_nop 1
v_permlane32_swap_b32 v50, v51
v_max_f32 v50, v50, v51
v_sub_f32 v48, v48, v50
v_exp_f32 v48, v48
s_nop 0
v_mul_f32 v49, v49, v48
s_nop 1
v_add_f32_dpp v49, v49, v49 quad_perm:[1,0,3,2] row_mask:0xf bank_mask:0xf
s_nop 1
v_add_f32_dpp v49, v49, v49 quad_perm:[2,3,0,1] row_mask:0xf bank_mask:0xf
s_nop 1
v_add_f32_dpp v49, v49, v49 row_half_mirror row_mask:0xf bank_mask:0xf
s_nop 1
v_add_f32_dpp v49, v49, v49 row_mirror row_mask:0xf bank_mask:0xf
v_mov_b32 v51, v49
s_nop 1
v_permlane16_swap_b32 v49, v51
v_add_f32 v49, v49, v51
v_mov_b32 v51, v49
s_nop 1
v_permlane32_swap_b32 v49, v51
v_add_f32 v49, v49, v51
v_rcp_f32 v49, v49
s_nop 0
v_mul_f32 v48, v48, v49
ds_write_b32 v20, v48
s_waitcnt lgkmcnt(0)
ds_read_b128 v[40:43], v21
ds_read_b128 v[44:47], v21 offset:16
s_waitcnt lgkmcnt(0)
v_cvt_pk_bf16_f32 v52, v40, v41
v_cvt_pk_bf16_f32 v53, v42, v43
v_cvt_pk_bf16_f32 v54, v44, v45
v_cvt_pk_bf16_f32 v55, v46, v47
v_lshlrev_b32 v60, 16, v52
v_and_b32 v61, 0xffff0000, v52
v_sub_f32 v40, v40, v60
v_sub_f32 v41, v41, v61
v_cvt_pk_bf16_f32 v56, v40, v41
v_lshlrev_b32 v60, 16, v53
v_and_b32 v61, 0xffff0000, v53
v_sub_f32 v42, v42, v60
v_sub_f32 v43, v43, v61
v_cvt_pk_bf16_f32 v57, v42, v43
v_lshlrev_b32 v60, 16, v54
v_and_b32 v61, 0xffff0000, v54
v_sub_f32 v44, v44, v60
v_sub_f32 v45, v45, v61
v_cvt_pk_bf16_f32 v58, v44, v45
v_lshlrev_b32 v60, 16, v55
v_and_b32 v61, 0xffff0000, v55
v_sub_f32 v46, v46, v60
v_sub_f32 v47, v47, v61
v_cvt_pk_bf16_f32 v59, v46, v47
v_cndmask_b32 v52, v52, v56, s[70:71]
v_cndmask_b32 v53, v53, v57, s[70:71]
v_cndmask_b32 v54, v54, v58, s[70:71]
v_cndmask_b32 v55, v55, v59, s[70:71]
v_perm_b32 v192, v52, v52, v4
v_perm_b32 v193, v52, v52, v5
v_perm_b32 v194, v52, v52, v6
v_perm_b32 v195, v52, v52, v7
v_perm_b32 v196, v52, v52, v8
v_perm_b32 v197, v52, v52, v9
v_perm_b32 v198, v52, v52, v10
v_perm_b32 v199, v52, v52, v11
v_perm_b32 v200, v53, v53, v4
v_perm_b32 v201, v53, v53, v5
v_perm_b32 v202, v53, v53, v6
v_perm_b32 v203, v53, v53, v7
v_perm_b32 v204, v53, v53, v8
v_perm_b32 v205, v53, v53, v9
v_perm_b32 v206, v53, v53, v10
v_perm_b32 v207, v53, v53, v11
v_perm_b32 v208, v54, v54, v4
v_perm_b32 v209, v54, v54, v5
v_perm_b32 v210, v54, v54, v6
v_perm_b32 v211, v54, v54, v7
v_perm_b32 v212, v54, v54, v8
v_perm_b32 v213, v54, v54, v9
v_perm_b32 v214, v54, v54, v10
v_perm_b32 v215, v54, v54, v11
v_perm_b32 v216, v55, v55, v4
v_perm_b32 v217, v55, v55, v5
v_perm_b32 v218, v55, v55, v6
v_perm_b32 v219, v55, v55, v7
v_perm_b32 v220, v55, v55, v8
v_perm_b32 v221, v55, v55, v9
v_perm_b32 v222, v55, v55, v10
v_perm_b32 v223, v55, v55, v11
s_waitcnt vmcnt(7)
v_mfma_f32_16x16x32_bf16 v[40:43], v[192:195], v[160:163], 0
s_waitcnt vmcnt(6)
v_mfma_f32_16x16x32_bf16 v[44:47], v[196:199], v[164:167], 0
s_waitcnt vmcnt(5)
v_mfma_f32_16x16x32_bf16 v[40:43], v[200:203], v[168:171], v[40:43]
s_waitcnt vmcnt(4)
v_mfma_f32_16x16x32_bf16 v[44:47], v[204:207], v[172:175], v[44:47]
s_waitcnt vmcnt(3)
v_mfma_f32_16x16x32_bf16 v[40:43], v[208:211], v[176:179], v[40:43]
s_waitcnt vmcnt(2)
v_mfma_f32_16x16x32_bf16 v[44:47], v[212:215], v[180:183], v[44:47]
s_waitcnt vmcnt(1)
v_mfma_f32_16x16x32_bf16 v[40:43], v[216:219], v[184:187], v[40:43]
s_waitcnt vmcnt(0)
v_mfma_f32_16x16x32_bf16 v[44:47], v[220:223], v[188:191], v[44:47]
s_nop 7
v_pk_add_f32 v[40:41], v[40:41], v[44:45]
v_pk_add_f32 v[42:43], v[42:43], v[46:47]
ds_write_b128 v22, v[40:43]
s_waitcnt lgkmcnt(0)
s_barrier
ds_read_b128 v[160:163], v23 offset:0
ds_read_b128 v[164:167], v23 offset:512
ds_read_b128 v[168:171], v23 offset:1024
ds_read_b128 v[172:175], v23 offset:1536
ds_read_b128 v[176:179], v23 offset:64
ds_read_b128 v[180:183], v23 offset:576
ds_read_b128 v[184:187], v23 offset:1088
ds_read_b128 v[188:191], v23 offset:1600
s_waitcnt lgkmcnt(4)
v_pk_add_f32 v[160:161], v[160:161], v[164:165]
v_pk_add_f32 v[162:163], v[162:163], v[166:167]
v_pk_add_f32 v[168:169], v[168:169], v[172:173]
v_pk_add_f32 v[170:171], v[170:171], v[174:175]
v_pk_add_f32 v[160:161], v[160:161], v[168:169]
v_pk_add_f32 v[162:163], v[162:163], v[170:171]
v_cvt_pk_bf16_f32 v52, v160, v161
v_cvt_pk_bf16_f32 v53, v162, v163
s_waitcnt lgkmcnt(0)
v_pk_add_f32 v[176:177], v[176:177], v[180:181]
v_pk_add_f32 v[178:179], v[178:179], v[182:183]
v_pk_add_f32 v[184:185], v[184:185], v[188:189]
v_pk_add_f32 v[186:187], v[186:187], v[190:191]
v_pk_add_f32 v[176:177], v[176:177], v[184:185]
v_pk_add_f32 v[178:179], v[178:179], v[186:187]
v_cvt_pk_bf16_f32 v54, v176, v177
v_cvt_pk_bf16_f32 v55, v178, v179
v_perm_b32 v192, v52, v52, v4
v_perm_b32 v193, v52, v52, v5
v_perm_b32 v194, v52, v52, v6
v_perm_b32 v195, v52, v52, v7
v_perm_b32 v196, v52, v52, v8
v_perm_b32 v197, v52, v52, v9
v_perm_b32 v198, v52, v52, v10
v_perm_b32 v199, v52, v52, v11
v_mfma_f32_16x16x32_bf16 v[40:43], v[192:195], v[64:67], 0
v_mfma_f32_16x16x32_bf16 v[44:47], v[192:195], v[68:71], 0
v_perm_b32 v200, v53, v53, v4
v_perm_b32 v201, v53, v53, v5
v_perm_b32 v202, v53, v53, v6
v_perm_b32 v203, v53, v53, v7
v_mfma_f32_16x16x32_bf16 v[40:43], v[196:199], v[72:75], v[40:43]
v_mfma_f32_16x16x32_bf16 v[44:47], v[196:199], v[76:79], v[44:47]
v_perm_b32 v204, v53, v53, v8
v_perm_b32 v205, v53, v53, v9
v_perm_b32 v206, v53, v53, v10
v_perm_b32 v207, v53, v53, v11
v_mfma_f32_16x16x32_bf16 v[40:43], v[200:203], v[80:83], v[40:43]
v_mfma_f32_16x16x32_bf16 v[44:47], v[200:203], v[84:87], v[44:47]
v_perm_b32 v208, v54, v54, v4
v_perm_b32 v209, v54, v54, v5
v_perm_b32 v210, v54, v54, v6
v_perm_b32 v211, v54, v54, v7
v_mfma_f32_16x16x32_bf16 v[40:43], v[204:207], v[88:91], v[40:43]
v_mfma_f32_16x16x32_bf16 v[44:47], v[204:207], v[92:95], v[44:47]
v_perm_b32 v212, v54, v54, v8
v_perm_b32 v213, v54, v54, v9
v_perm_b32 v214, v54, v54, v10
v_perm_b32 v215, v54, v54, v11
v_mfma_f32_16x16x32_bf16 v[40:43], v[208:211], v[96:99], v[40:43]
v_mfma_f32_16x16x32_bf16 v[44:47], v[208:211], v[100:103], v[44:47]
v_perm_b32 v216, v55, v55, v4
v_perm_b32 v217, v55, v55, v5
v_perm_b32 v218, v55, v55, v6
v_perm_b32 v219, v55, v55, v7
v_mfma_f32_16x16x32_bf16 v[40:43], v[212:215], v[104:107], v[40:43]
v_mfma_f32_16x16x32_bf16 v[44:47], v[212:215], v[108:111], v[44:47]
v_perm_b32 v220, v55, v55, v8
v_perm_b32 v221, v55, v55, v9
v_perm_b32 v222, v55, v55, v10
v_perm_b32 v223, v55, v55, v11
v_mfma_f32_16x16x32_bf16 v[40:43], v[216:219], v[112:115], v[40:43]
v_mfma_f32_16x16x32_bf16 v[44:47], v[216:219], v[116:119], v[44:47]
s_nop 1
v_mfma_f32_16x16x32_bf16 v[40:43], v[220:223], v[120:123], v[40:43]
v_mfma_f32_16x16x32_bf16 v[44:47], v[220:223], v[124:127], v[44:47]
s_nop 7
ds_write_b128 v24, v[40:43]
ds_write_b128 v24, v[44:47] offset:512
s_waitcnt lgkmcnt(0)
s_barrier
s_mov_b32 exec_hi, 0
ds_read_b128 v[160:163], v25 offset:0
ds_read_b128 v[164:167], v25 offset:2048
ds_read_b128 v[168:171], v25 offset:4096
ds_read_b128 v[172:175], v25 offset:6144
s_waitcnt lgkmcnt(0)
v_pk_add_f32 v[160:161], v[160:161], v[164:165]
v_pk_add_f32 v[162:163], v[162:163], v[166:167]
v_pk_add_f32 v[168:169], v[168:169], v[172:173]
v_pk_add_f32 v[170:171], v[170:171], v[174:175]
v_pk_add_f32 v[160:161], v[160:161], v[168:169]
v_pk_add_f32 v[162:163], v[162:163], v[170:171]
buffer_store_dwordx4 v[160:163], v26, s[12:15], s64 offen sc1
s_mov_b64 exec, -1
s_sleep 12
buffer_load_dwordx2 v[176:177], v27, s[12:15], s65 offen offset:0 sc1
buffer_load_dwordx2 v[178:179], v27, s[12:15], s65 offen offset:256 sc1
buffer_load_dwordx2 v[180:181], v27, s[12:15], s65 offen offset:512 sc1
buffer_load_dwordx2 v[182:183], v27, s[12:15], s65 offen offset:768 sc1
buffer_load_dwordx2 v[184:185], v27, s[12:15], s65 offen offset:1024 sc1
buffer_load_dwordx2 v[186:187], v27, s[12:15], s65 offen offset:1280 sc1
buffer_load_dwordx2 v[188:189], v27, s[12:15], s65 offen offset:1536 sc1
buffer_load_dwordx2 v[190:191], v27, s[12:15], s65 offen offset:1792 sc1
s_waitcnt vmcnt(0)
s_mov_b32 s24, 100000
L_cx_25:
v_max3_u32 v50, v176, v177, v178
v_max3_u32 v50, v50, v179, v180
v_max3_u32 v50, v50, v181, v182
v_max3_u32 v50, v50, v183, v184
v_max3_u32 v50, v50, v185, v186
v_max3_u32 v50, v50, v187, v188
v_max3_u32 v50, v50, v189, v190
v_max_u32 v50, v50, v191
v_cmp_eq_u32 vcc, -1, v50
s_nop 1
s_cmp_eq_u64 vcc, 0
s_cbranch_scc1 L_cxd_26
s_sub_u32 s24, s24, 1
s_cmp_eq_u32 s24, 0
s_cbranch_scc1 L_cxd_26
s_sleep 4
buffer_load_dwordx2 v[176:177], v27, s[12:15], s65 offen offset:0 sc1
buffer_load_dwordx2 v[178:179], v27, s[12:15], s65 offen offset:256 sc1
buffer_load_dwordx2 v[180:181], v27, s[12:15], s65 offen offset:512 sc1
buffer_load_dwordx2 v[182:183], v27, s[12:15], s65 offen offset:768 sc1
buffer_load_dwordx2 v[184:185], v27, s[12:15], s65 offen offset:1024 sc1
buffer_load_dwordx2 v[186:187], v27, s[12:15], s65 offen offset:1280 sc1
buffer_load_dwordx2 v[188:189], v27, s[12:15], s65 offen offset:1536 sc1
buffer_load_dwordx2 v[190:191], v27, s[12:15], s65 offen offset:1792 sc1
s_waitcnt vmcnt(0)
s_branch L_cx_25
L_cxd_26:
v_pk_add_f32 v[176:177], v[176:177], v[178:179]
v_pk_add_f32 v[180:181], v[180:181], v[182:183]
v_pk_add_f32 v[184:185], v[184:185], v[186:187]
v_pk_add_f32 v[188:189], v[188:189], v[190:191]
v_pk_add_f32 v[176:177], v[176:177], v[180:181]
v_pk_add_f32 v[184:185], v[184:185], v[188:189]
v_pk_add_f32 v[176:177], v[176:177], v[184:185]
v_cvt_pk_bf16_f32 v52, v176, v177
v_perm_b32 v192, v52, v52, v4
v_perm_b32 v193, v52, v52, v5
v_perm_b32 v194, v52, v52, v6
v_perm_b32 v195, v52, v52, v7
v_perm_b32 v196, v52, v52, v8
v_perm_b32 v197, v52, v52, v9
v_perm_b32 v198, v52, v52, v10
v_perm_b32 v199, v52, v52, v11
v_mfma_f32_16x16x32_bf16 v[224:227], v[192:195], v[128:131], 0
v_mfma_f32_16x16x32_bf16 v[228:231], v[192:195], v[132:135], 0
v_mfma_f32_16x16x32_bf16 v[232:235], v[192:195], v[136:139], 0
v_mfma_f32_16x16x32_bf16 v[236:239], v[192:195], v[140:143], 0
v_mfma_f32_16x16x32_bf16 v[224:227], v[196:199], v[144:147], v[224:227]
v_mfma_f32_16x16x32_bf16 v[228:231], v[196:199], v[148:151], v[228:231]
v_mfma_f32_16x16x32_bf16 v[232:235], v[196:199], v[152:155], v[232:235]
v_mfma_f32_16x16x32_bf16 v[236:239], v[196:199], v[156:159], v[236:239]
s_nop 4
ds_write_b128 v16, v[224:227] offset:0
ds_write_b128 v16, v[228:231] offset:512
ds_write_b128 v16, v[232:235] offset:1024
ds_write_b128 v16, v[236:239] offset:1536
s_waitcnt lgkmcnt(0)
s_barrier
s_mov_b64 exec, s[68:69]
ds_read_b128 v[160:163], v17 offset:0
ds_read_b128 v[164:167], v17 offset:4096
ds_read_b128 v[168:171], v17 offset:8192
ds_read_b128 v[172:175], v17 offset:12288
s_waitcnt lgkmcnt(0)
v_pk_add_f32 v[160:161], v[160:161], v[164:165]
v_pk_add_f32 v[162:163], v[162:163], v[166:167]
v_pk_add_f32 v[168:169], v[168:169], v[172:173]
v_pk_add_f32 v[170:171], v[170:171], v[174:175]
v_pk_add_f32 v[160:161], v[160:161], v[168:169]
v_pk_add_f32 v[162:163], v[162:163], v[170:171]
buffer_store_dwordx4 v[160:163], v19, s[12:15], s66 offen sc1
s_mov_b64 exec, -1
s_cmp_ge_u32 s9, 56
s_cbranch_scc1 L_fin
s_sleep 20
buffer_load_dwordx4 v[32:35], v12, s[12:15], s67 offen offset:0 sc1
buffer_load_dwordx4 v[36:39], v12, s[12:15], s67 offen offset:1024 sc1
s_waitcnt vmcnt(0)
s_mov_b32 s24, 100000
L_ob_27:
v_max3_u32 v64, v32, v33, v34
v_max3_u32 v64, v64, v35, v36
v_max3_u32 v64, v64, v37, v38
v_max_u32 v64, v64, v39
v_cmp_eq_u32 vcc, -1, v64
s_nop 1
s_cmp_eq_u64 vcc, 0
s_cbranch_scc1 L_obd_28
s_sub_u32 s24, s24, 1
s_cmp_eq_u32 s24, 0
s_cbranch_scc1 L_obd_28
s_sleep 8
buffer_load_dwordx4 v[32:35], v12, s[12:15], s67 offen offset:0 sc1
buffer_load_dwordx4 v[36:39], v12, s[12:15], s67 offen offset:1024 sc1
s_waitcnt vmcnt(0)
s_branch L_ob_27
L_obd_28:
v_pk_add_f32 v[32:33], v[32:33], v[36:37]
v_pk_add_f32 v[34:35], v[34:35], v[38:39]
s_nop 1
v_add_f32_dpp v32, v32, v32 row_ror:4 row_mask:0xf bank_mask:0xf
v_add_f32_dpp v33, v33, v33 row_ror:4 row_mask:0xf bank_mask:0xf
v_add_f32_dpp v34, v34, v34 row_ror:4 row_mask:0xf bank_mask:0xf
v_add_f32_dpp v35, v35, v35 row_ror:4 row_mask:0xf bank_mask:0xf
s_nop 1
v_add_f32_dpp v32, v32, v32 row_ror:8 row_mask:0xf bank_mask:0xf
v_add_f32_dpp v33, v33, v33 row_ror:8 row_mask:0xf bank_mask:0xf
v_add_f32_dpp v34, v34, v34 row_ror:8 row_mask:0xf bank_mask:0xf
v_add_f32_dpp v35, v35, v35 row_ror:8 row_mask:0xf bank_mask:0xf
s_lshl_b32 s16, s27, 8
v_lshlrev_b32 v40, 6, v3
v_add_u32 v40, v40, v14
v_add_u32 v40, s16, v40
v_cmp_gt_u32 vcc, 4, v2
s_and_saveexec_b64 s[22:23], vcc
ds_write_b128 v40, v[32:35] offset:20480
s_mov_b64 exec, -1
s_waitcnt lgkmcnt(0)
s_barrier
s_cmp_lg_u32 s27, 0
s_cbranch_scc1 L_fin
ds_read_b128 v[32:35], v12 offset:20480
s_waitcnt lgkmcnt(0)
s_nop 1
v_add_f32_dpp v32, v32, v32 row_ror:4 row_mask:0xf bank_mask:0xf
v_add_f32_dpp v33, v33, v33 row_ror:4 row_mask:0xf bank_mask:0xf
v_add_f32_dpp v34, v34, v34 row_ror:4 row_mask:0xf bank_mask:0xf
v_add_f32_dpp v35, v35, v35 row_ror:4 row_mask:0xf bank_mask:0xf
s_nop 1
v_add_f32_dpp v32, v32, v32 row_ror:8 row_mask:0xf bank_mask:0xf
v_add_f32_dpp v33, v33, v33 row_ror:8 row_mask:0xf bank_mask:0xf
v_add_f32_dpp v34, v34, v34 row_ror:8 row_mask:0xf bank_mask:0xf
v_add_f32_dpp v35, v35, v35 row_ror:8 row_mask:0xf bank_mask:0xf
v_mov_b32 v40, v32
v_mov_b32 v41, v33
v_mov_b32 v42, v34
v_mov_b32 v43, v35
s_nop 1
v_permlane16_swap_b32 v32, v40
v_permlane16_swap_b32 v33, v41
v_permlane16_swap_b32 v34, v42
v_permlane16_swap_b32 v35, v43
v_add_f32 v32, v32, v40
v_add_f32 v33, v33, v41
v_add_f32 v34, v34, v42
v_add_f32 v35, v35, v43
v_mov_b32 v40, v32
v_mov_b32 v41, v33
v_mov_b32 v42, v34
v_mov_b32 v43, v35
s_nop 1
v_permlane32_swap_b32 v32, v40
v_permlane32_swap_b32 v33, v41
v_permlane32_swap_b32 v34, v42
v_permlane32_swap_b32 v35, v43
v_add_f32 v32, v32, v40
v_add_f32 v33, v33, v41
v_add_f32 v34, v34, v42
v_add_f32 v35, v35, v43
v_cvt_pk_bf16_f32 v36, v32, v33
v_cvt_pk_bf16_f32 v37, v34, v35
s_cmp_ge_u32 s9, 28
s_cselect_b32 s16, 896, 0
s_mul_i32 s17, s4, 896
s_add_u32 s16, s16, s17
s_lshl_b32 s17, s9, 5
s_add_u32 s16, s16, s17
v_lshlrev_b32 v40, 3, v1
s_mov_b64 exec, 15
buffer_store_dwordx2 v[36:37], v40, s[60:63], s16 offen
s_mov_b64 exec, -1
s_cmp_lg_u32 s9, 0
s_cbranch_scc1 L_fin
s_lshl_b32 s16, s4, 8
s_add_u32 s16, s16, 524288
v_mov_b32 v40, s11
v_mov_b32 v41, 0
s_mov_b64 exec, 1
buffer_store_dword v40, v41, s[12:15], s16 offen sc1
s_mov_b64 exec, -1
L_fin:
L_end:
L_codeend:
s_endpgm
.section .rodata,"a"
.p2align 6
.amdhsa_kernel concat_heads__compressed_kv_cla__compressed_kv_cla__decode_kernel
  .amdhsa_next_free_vgpr 256
  .amdhsa_next_free_sgpr 102
  .amdhsa_accum_offset 256
  .amdhsa_group_segment_fixed_size 0
  .amdhsa_kernarg_size 120
  .amdhsa_user_sgpr_count 2
  .amdhsa_user_sgpr_kernarg_segment_ptr 1
  .amdhsa_system_sgpr_workgroup_id_x 1
.end_amdhsa_kernel
```
